```python
import torch

def _softmax(x, axis=-1):
    return torch.softmax(x, dim=axis)
def _gelu(x):
    return torch.nn.functional.gelu(x, approximate="tanh")
def _silu(x):
    return torch.nn.functional.silu(x)
def _sigmoid(x):
    return torch.sigmoid(x)
def _layernorm(x, axis=-1, eps=1e-5):
    m = x.mean(dim=axis, keepdim=True)
    v = x.var(dim=axis, keepdim=True, unbiased=False)
    return (x - m) / torch.sqrt(v + eps)
def _scatter_add(tgt, idx, src, axis=0):
    return tgt.clone().index_add_(axis, idx, src)
def _segment_sum(src, seg, n):
    out = torch.zeros((n,) + src.shape[1:], dtype=src.dtype)
    return out.index_add_(0, seg, src)
def _pad(x, pw):
    flat = tuple(v for pair in reversed(pw) for v in pair)
    return torch.nn.functional.pad(x, flat)

kernel_name = 'standalone__gqa_softmax__prompt'

def setup_inputs():

    _w = (lambda a: (lambda t: t.to(torch.bfloat16) if t.is_floating_point() else t)(torch.as_tensor(a)))
    B, Hq, Hkv, Sq, Sk, D = 1, 32, 4, 2048, 2048, 128
    return {
        "q": _w((lambda *s: torch.randn(*s, dtype=torch.bfloat16) * 0.8)(B, Hq, Sq, D)),
        "k": _w((lambda *s: torch.randn(*s, dtype=torch.bfloat16) * 0.8)(B, Hkv, Sk, D)),
        "v": _w((lambda *s: torch.randn(*s, dtype=torch.bfloat16) * 0.05)(B, Hkv, Sk, D)),
    }

def reference(q, k, v):
    B, Hq, Sq, D = q.shape
    Hkv = k.shape[1]
    rep = Hq // Hkv
    k = (lambda x, n, axis: torch.repeat_interleave(x, n, dim=axis))(k, rep, axis=1)
    v = (lambda x, n, axis: torch.repeat_interleave(x, n, dim=axis))(v, rep, axis=1)
    scale = D ** -0.5
    scores = torch.einsum("bhqd,bhkd->bhqk", q, k) * scale
    p = _softmax(scores, axis=-1)
    return torch.einsum("bhqk,bhkd->bhqd", p, v)
```

```asm
; @launch grid=(256,1,1) block=(256,1,1) lds=163840
.amdgcn_target "amdgcn-amd-amdhsa--gfx950"
.text
.globl standalone__gqa_softmax__prompt_kernel
.p2align 8
.type standalone__gqa_softmax__prompt_kernel,@function
standalone__gqa_softmax__prompt_kernel:
    s_cmp_ge_u32 s2, 256
    s_cbranch_scc1 L_end
    s_load_dwordx4 s[28:31], s[0:1], 0
    s_load_dwordx4 s[32:35], s[0:1], 16
    s_getpc_b64 s[50:51]
L_pc:
    s_bfe_u32 s46, s2, 0x30003
    s_lshl_b32 s46, s46, 12
    v_lshl_add_u32 v254, v0, 4, s46
    v_min_u32 v254, L_end-L_pc, v254
    global_load_dword v255, v254, s[50:51]
    v_lshrrev_b32 v1, 6, v0
    v_and_b32 v197, 63, v0
    v_readfirstlane_b32 s20, v1
    s_and_b32 s3, s2, 7
    s_lshr_b32 s3, s3, 1
    s_lshr_b32 s40, s2, 3
    s_lshl_b32 s40, s40, 1
    s_and_b32 s41, s2, 1
    s_add_u32 s40, s40, s41
    s_lshl2_add_u32 s40, s40, s20
    s_lshl_b32 s40, s40, 14
    s_lshl_b32 s41, s3, 22
    s_add_u32 s40, s40, s41
    s_lshl_b32 s3, s3, 19
    s_lshl_b32 s21, s20, 11
    s_add_u32 s22, s21, 65536
    s_lshl_b32 s23, s20, 13
    s_add_u32 s27, s23, 98304
    s_add_u32 s23, s23, 131072
    s_mov_b32 s24, 0
    s_mov_b32 s25, 0
    v_and_b32 v1, 15, v197
    v_lshrrev_b32 v2, 4, v197
    s_lshl_b32 s41, s20, 3
    v_add_u32 v3, s41, v2
    s_mov_b32 s6, 0x80000
    s_mov_b32 s7, 0x20000
    s_mov_b32 s14, 16384
    s_mov_b32 s15, 0x20000
    s_mov_b32 s10, 0x80000
    s_mov_b32 s11, 0x20000
    s_mov_b32 s18, 16384
    s_mov_b32 s19, 0x20000
    s_mov_b32 s42, 4096
    s_mov_b32 s43, 8192
    s_mov_b32 s44, 12288
    v_add_u32 v4, 0, v3
    v_and_b32 v5, 15, v4
    v_xor_b32 v5, v5, v1
    v_lshlrev_b32 v5, 4, v5
    v_lshl_add_u32 v188, v3, 8, v5
    v_xor_b32 v5, v2, v1
    v_xor_b32 v5, 0, v5
    v_lshlrev_b32 v5, 4, v5
    v_lshl_add_u32 v190, v3, 8, v5
    v_add_u32 v4, 4, v3
    v_and_b32 v5, 15, v4
    v_xor_b32 v5, v5, v1
    v_lshlrev_b32 v5, 4, v5
    v_lshl_add_u32 v189, v3, 8, v5
    v_xor_b32 v5, v2, v1
    v_xor_b32 v5, 8, v5
    v_lshlrev_b32 v5, 4, v5
    v_lshl_add_u32 v191, v3, 8, v5
    v_xor_b32 v4, v1, v2
    v_lshlrev_b32 v4, 4, v4
    v_lshl_add_u32 v200, v2, 8, v4
    v_xor_b32 v201, 64, v200
    v_xor_b32 v202, 0x80, v200
    v_xor_b32 v203, 0xc0, v200
    s_waitcnt lgkmcnt(0)
    s_add_u32 s4, s30, s3
    s_addc_u32 s5, s31, 0
    s_add_u32 s12, s28, s40
    s_addc_u32 s13, s29, 0
    s_add_u32 s8, s32, s3
    s_addc_u32 s9, s33, 0
    s_add_u32 s16, s34, s40
    s_addc_u32 s17, s35, 0
    s_add_u32 m0, s27, 32768
    s_nop 0
    buffer_load_dwordx4 v200, s[12:15], 0 offen nt lds
    buffer_load_dwordx4 v201, s[12:15], 0 offen offset:1024 nt lds
    buffer_load_dwordx4 v202, s[12:15], 0 offen offset:2048 nt lds
    buffer_load_dwordx4 v203, s[12:15], 0 offen offset:3072 nt lds
    s_add_u32 m0, s21, 0
    s_nop 0
    buffer_load_dwordx4 v188, s[4:7], s24 offen lds
    buffer_load_dwordx4 v189, s[4:7], s24 offen offset:1024 lds
    s_add_u32 m0, s21, 8192
    s_add_u32 s24, s24, 8192
    buffer_load_dwordx4 v188, s[4:7], s24 offen lds
    buffer_load_dwordx4 v189, s[4:7], s24 offen offset:1024 lds
    s_add_u32 s24, s24, 8192
    s_add_u32 m0, s27, 36864
    s_nop 0
    buffer_load_dwordx4 v200, s[12:15], s42 offen nt lds
    buffer_load_dwordx4 v201, s[12:15], s42 offen offset:1024 nt lds
    buffer_load_dwordx4 v202, s[12:15], s42 offen offset:2048 nt lds
    buffer_load_dwordx4 v203, s[12:15], s42 offen offset:3072 nt lds
    s_mov_b64 s[38:39], 0
    v_lshl_add_u32 v176, v1, 8, v4
    v_accvgpr_write_b32 a124, 0
    v_lshrrev_b32 v4, 2, v197
    v_and_b32 v5, 1, v197
    v_and_b32 v6, 2, v197
    v_lshlrev_b32 v7, 3, v5
    v_and_b32 v10, 1, v1
    v_lshl_add_u32 v7, v4, 8, v7
    v_accvgpr_write_b32 a227, 0
    v_and_b32 v15, 1, v2
    v_lshl_add_u32 v7, v6, 5, v7
    v_add_u32 v7, 65536, v7
    v_and_b32 v4, 3, v4
    v_accvgpr_write_b32 a231, 0
    v_lshl_add_u32 v7, v4, 4, v7
    v_lshl_add_u32 v180, v15, 7, v7
    v_lshlrev_b32 v7, 3, v1
    v_lshl_add_u32 v7, v2, 10, v7
    v_add_u32 v204, s27, v176
    v_add_u32 v208, s23, v7
    v_mov_b32 v12, 47576
    v_cmp_eq_u32 vcc, 0, v2
    v_mul_u32_u24 v7, 0x90, v6
    v_lshl_add_u32 v7, v5, 6, v7
    v_lshl_add_u32 v7, v4, 3, v7
    v_cndmask_b32 v199, 0, 1.0, vcc
    v_mov_b64 v[92:93], 0
    v_and_b32 v5, 7, v197
    v_xor_b32 v184, 128, v180
    v_lshrrev_b32 v8, 1, v1
    v_lshlrev_b32 v5, 4, v5
    v_xor_b32 v178, 0x80, v176
    v_xor_b32 v209, 32, v208
    v_lshl_add_u32 v7, v2, 9, v7
    v_lshl_add_u32 v7, v15, 7, v7
    v_xor_b32 v182, 32, v180
    v_lshrrev_b32 v4, 3, v197
    v_lshlrev_b32 v9, 1, v2
    v_lshl_add_u32 v248, v4, 8, v5
    v_add_u32 v210, s23, v7
    v_xor_b32 v183, 48, v180
    v_xor_b32 v4, v2, v197
    v_mov_b64 v[78:79], 0
    v_and_b32 v4, 2, v4
    v_lshlrev_b32 v198, 4, v2
    v_add_u32 v206, s27, v178
    v_xor_b32 v177, 64, v176
    v_accvgpr_write_b32 a125, 0
    v_xor_b32 v253, 0xa0, v210
    s_mov_b32 s37, 0x3e0293ee
    v_cmp_eq_u32 vcc, 0, v4
    v_xor_b32 v179, 0xc0, v176
    v_accvgpr_write_b32 a224, 0
    v_xor_b32 v185, 144, v180
    s_add_u32 m0, s21, 16384
    v_and_b32 v7, 1, v197
    v_mov_b32 v5, 0x3f803f80
    v_accvgpr_write_b32 a116, 0
    v_cndmask_b32 v192, 0, v5, vcc
    v_add_u32 v207, s27, v179
    v_mov_b32 v193, v192
    v_accvgpr_write_b32 a228, 0
    s_mov_b32 s36, 0x3e0293ee
    v_mov_b32 v194, v192
    v_cmp_eq_u32 vcc, 0, v7
    v_mov_b32 v11, 15875
    v_xor_b32 v252, 0x80, v210
    v_lshlrev_b32 v10, 4, v10
    v_mov_b32 v195, v192
    v_xor_b32 v187, 176, v180
    v_accvgpr_write_b32 a225, 0
    v_mov_b64 v[94:95], 0
    v_xor_b32 v181, 16, v180
    v_accvgpr_write_b32 a229, 0
    v_xor_b32 v186, 160, v180
    v_mov_b32 v5, 0x44444444
    v_accvgpr_write_b32 a120, 0
    v_mov_b32 v7, 0xeeeeeeee
    s_mov_b32 s45, 0x23000000
    v_lshlrev_b32 v11, v10, v11
    v_cndmask_b32 v196, v7, v5, vcc
    v_mov_b64 v[76:77], 0
    v_cmp_eq_u32 vcc, v8, v9
    v_lshlrev_b32 v12, v10, v12
    v_accvgpr_write_b32 a117, 0
    v_cndmask_b32 v14, 0, v12, vcc
    v_xor_b32 v211, 32, v210
    v_cndmask_b32 v13, 0, v11, vcc
    v_add_u32 v9, 1, v9
    v_accvgpr_write_b32 a122, v14
    v_add_u32 v205, s27, v177
    v_accvgpr_write_b32 a230, 0
    v_cmp_eq_u32 vcc, v8, v9
    v_add_u32 v212, 65536, v248
    s_nop 0
    v_cndmask_b32 v11, 0, v11, vcc
    v_accvgpr_write_b32 a118, v13
    v_accvgpr_write_b32 a226, 0
    v_accvgpr_write_b32 a121, 0
    v_cndmask_b32 v12, 0, v12, vcc
    v_accvgpr_write_b32 a119, v11
    v_accvgpr_write_b32 a123, v12
    buffer_load_dwordx4 v188, s[4:7], s24 offen lds
    buffer_load_dwordx4 v189, s[4:7], s24 offen offset:1024 lds
    s_add_u32 m0, s22, 0
    s_nop 0
    buffer_load_dwordx4 v190, s[8:11], s25 offen lds
    s_waitcnt vmcnt(11)
    ds_read_b128 v[112:115], v204 offset:32768
    ds_read_b128 v[116:119], v205 offset:32768
    ds_read_b128 v[120:123], v206 offset:32768
    ds_read_b128 v[124:127], v207 offset:32768
    buffer_load_dwordx4 v191, s[8:11], s25 offen offset:1024 lds
    s_waitcnt lgkmcnt(3)
    v_mfma_f32_16x16x32_bf16 v[0:3], a[118:121], v[112:115], 0
    v_mfma_f32_16x16x32_bf16 v[0:3], a[122:125], v[112:115], v[0:3]
    s_add_u32 m0, s27, 0
    v_mfma_f32_16x16x32_bf16 v[4:7], a[120:123], v[112:115], 0
    buffer_load_dwordx4 v200, s[12:15], s43 offen nt lds
    buffer_load_dwordx4 v201, s[12:15], s43 offen offset:1024 nt lds
    v_mfma_f32_16x16x32_bf16 v[4:7], a[116:119], v[112:115], v[4:7]
    s_waitcnt lgkmcnt(0)
    v_mfma_f32_16x16x32_bf16 v[32:35], a[118:121], v[116:119], 0
    s_add_u32 s24, s24, 8192
    v_cvt_pk_bf16_f32 v112, v0, v1
    v_cvt_pk_bf16_f32 v113, v2, v3
    v_mfma_f32_16x16x32_bf16 v[32:35], a[122:125], v[116:119], v[32:35]
    s_nop 1
    v_cvt_pk_bf16_f32 v114, v4, v5
    v_mfma_f32_16x16x32_bf16 v[36:39], a[120:123], v[116:119], 0
    v_mfma_f32_16x16x32_bf16 v[36:39], a[116:119], v[116:119], v[36:39]
    s_add_u32 s25, s25, 8192
    s_nop 1
    v_cvt_pk_bf16_f32 v117, v34, v35
    v_cvt_pk_bf16_f32 v115, v6, v7
    s_nop 2
    v_cvt_pk_bf16_f32 v118, v36, v37
    v_cvt_pk_bf16_f32 v119, v38, v39
    v_mfma_f32_16x16x32_bf16 v[36:39], a[120:123], v[124:127], 0
    s_waitcnt vmcnt(10)
    s_barrier
    v_mfma_f32_16x16x32_bf16 v[36:39], a[116:119], v[124:127], v[36:39]
    ds_read_b128 a[240:243], v198 offset:128
    ds_read_b128 a[132:135], v177 offset:0
    v_cvt_pk_bf16_f32 v116, v32, v33
    v_mfma_f32_16x16x32_bf16 v[32:35], a[118:121], v[124:127], 0
    ds_read_b128 a[232:235], v198 offset:0
    buffer_load_dwordx4 v202, s[12:15], s43 offen offset:2048 nt lds
    ds_read_b128 a[244:247], v198 offset:192
    v_mfma_f32_16x16x32_bf16 v[32:35], a[122:125], v[124:127], v[32:35]
    ds_read_b128 a[200:203], v178 offset:8192
    v_cvt_pk_bf16_f32 v126, v36, v37
    v_mfma_f32_16x16x32_bf16 v[4:7], a[120:123], v[120:123], 0
    ds_read_b128 a[148:151], v177 offset:4096
    v_mfma_f32_16x16x32_bf16 v[4:7], a[116:119], v[120:123], v[4:7]
    buffer_load_dwordx4 v203, s[12:15], s43 offen offset:3072 nt lds
    ds_read_b128 a[236:239], v198 offset:64
    s_nop 0
    v_cvt_pk_bf16_f32 v125, v34, v35
    ds_read_b128 a[192:195], v176 offset:8192
    v_mfma_f32_16x16x32_bf16 v[0:3], a[118:121], v[120:123], 0
    ds_read_b128 a[156:159], v179 offset:4096
    v_mfma_f32_16x16x32_bf16 v[0:3], a[122:125], v[120:123], v[0:3]
    s_add_u32 m0, s21, 24576
    v_cvt_pk_bf16_f32 v127, v38, v39
    s_waitcnt lgkmcnt(4)
    v_mfma_f32_16x16x32_bf16 v[96:99], a[232:235], v[112:115], 0
    ds_read_b128 a[212:215], v177 offset:12288
    v_cvt_pk_bf16_f32 v122, v4, v5
    ds_read_b128 a[144:147], v176 offset:4096
    v_cvt_pk_bf16_f32 v124, v32, v33
    s_waitcnt lgkmcnt(4)
    v_mfma_f32_16x16x32_bf16 v[96:99], a[236:239], v[116:119], v[96:99]
    ds_read_b128 a[152:155], v178 offset:4096
    v_cvt_pk_bf16_f32 v121, v2, v3
    v_cvt_pk_bf16_f32 v123, v6, v7
    v_cvt_pk_bf16_f32 v120, v0, v1
    buffer_load_dwordx4 v188, s[4:7], s24 offen lds
    s_nop 0
    v_mfma_f32_16x16x32_bf16 v[96:99], a[240:243], v[120:123], v[96:99]
    ds_read_b128 a[220:223], v179 offset:12288
    v_mfma_f32_16x16x32_bf16 v[96:99], a[244:247], v[124:127], v[96:99]
    ds_read_b128 a[208:211], v176 offset:12288
    s_nop 6
    v_add_f32 v96, 0x4d400000, v96
    ds_read_b128 a[196:199], v177 offset:8192
    v_sub_f32 v96, 0x4d400000, v96
    v_add_f32 v97, 0xc1500000, v96
    v_add_f32 v99, 0xc1500000, v96
    v_add_f32 v98, 0xc1500000, v96
    v_add_f32 v96, 0xc1500000, v96
    s_waitcnt lgkmcnt(2)
    s_nop 0
    v_mfma_f32_16x16x32_bf16 v[4:7], a[156:159], v[124:127], v[96:99]
    ds_read_b128 a[204:207], v179 offset:8192
    v_mfma_f32_16x16x32_bf16 v[4:7], a[152:155], v[120:123], v[4:7]
    buffer_load_dwordx4 v189, s[4:7], s24 offen offset:1024 lds
    v_mfma_f32_16x16x32_bf16 v[4:7], a[148:151], v[116:119], v[4:7]
    v_mfma_f32_16x16x32_bf16 v[4:7], a[144:147], v[112:115], v[4:7]
    s_add_u32 s24, s24, 8192
    ds_read_b128 a[216:219], v178 offset:12288
    ds_read_b128 a[136:139], v178 offset:0
    v_mfma_f32_16x16x32_bf16 v[32:35], a[192:195], v[112:115], v[96:99]
    s_waitcnt lgkmcnt(3)
    v_mfma_f32_16x16x32_bf16 v[32:35], a[196:199], v[116:119], v[32:35]
    v_mfma_f32_16x16x32_bf16 v[32:35], a[200:203], v[120:123], v[32:35]
    ds_read_b128 a[128:131], v176 offset:0
    v_exp_f32 v4, v4
    s_waitcnt lgkmcnt(3)
    v_mfma_f32_16x16x32_bf16 v[32:35], a[204:207], v[124:127], v[32:35]
    v_mfma_f32_16x16x32_bf16 v[36:39], a[220:223], v[124:127], v[96:99]
    s_waitcnt lgkmcnt(2)
    v_mfma_f32_16x16x32_bf16 v[36:39], a[216:219], v[120:123], v[36:39]
    v_mfma_f32_16x16x32_bf16 v[36:39], a[212:215], v[116:119], v[36:39]
    v_exp_f32 v6, v6
    v_mfma_f32_16x16x32_bf16 v[36:39], a[208:211], v[112:115], v[36:39]
    ds_read_b128 a[140:143], v179 offset:0
    s_add_u32 m0, s22, 8192
    v_exp_f32 v33, v33
    v_exp_f32 v32, v32
    s_waitcnt lgkmcnt(1)
    v_mfma_f32_16x16x32_bf16 v[0:3], a[128:131], v[112:115], v[96:99]
    v_exp_f32 v7, v7
    v_exp_f32 v35, v35
    buffer_load_dwordx4 v190, s[8:11], s25 offen lds
    v_exp_f32 v5, v5
    v_mfma_f32_16x16x32_bf16 v[0:3], a[132:135], v[116:119], v[0:3]
    v_exp_f32 v37, v37
    v_cvt_pk_bf16_f32 v67, v6, v7
    v_mfma_f32_16x16x32_bf16 v[0:3], a[136:139], v[120:123], v[0:3]
    s_waitcnt lgkmcnt(0)
    v_mfma_f32_16x16x32_bf16 v[0:3], a[140:143], v[124:127], v[0:3]
    v_exp_f32 v34, v34
    v_cvt_pk_bf16_f32 v80, v32, v33
    v_cvt_pk_bf16_f32 v66, v4, v5
    v_exp_f32 v36, v36
    s_nop 3
    v_exp_f32 v0, v0
    v_exp_f32 v39, v39
    v_exp_f32 v2, v2
    v_exp_f32 v1, v1
    v_exp_f32 v38, v38
    v_cvt_pk_bf16_f32 v82, v36, v37
    v_exp_f32 v3, v3
    s_nop 0
    v_cvt_pk_bf16_f32 v65, v2, v3
    s_waitcnt vmcnt(11)
    ds_read_b128 v[128:131], v204 offset:36864
    buffer_load_dwordx4 v191, s[8:11], s25 offen offset:1024 lds
    ds_read_b128 v[132:135], v205 offset:36864
    ds_read_b128 v[136:139], v206 offset:36864
    v_cvt_pk_bf16_f32 v81, v34, v35
    v_cvt_pk_bf16_f32 v83, v38, v39
    ds_read_b128 v[140:143], v207 offset:36864
    s_add_u32 s25, s25, 8192
    s_waitcnt lgkmcnt(3)
    v_mfma_f32_16x16x32_bf16 v[12:15], a[120:123], v[128:131], 0
    v_mfma_f32_16x16x32_bf16 v[12:15], a[116:119], v[128:131], v[12:15]
    v_mfma_f32_16x16x32_bf16 v[8:11], a[118:121], v[128:131], 0
    s_add_u32 m0, s21, 32768
    v_mfma_f32_16x16x32_bf16 v[8:11], a[122:125], v[128:131], v[8:11]
    buffer_load_dwordx4 v188, s[4:7], s24 offen lds
    s_waitcnt lgkmcnt(0)
    v_mfma_f32_16x16x32_bf16 v[40:43], a[118:121], v[132:135], 0
    buffer_load_dwordx4 v189, s[4:7], s24 offen offset:1024 lds
    s_add_u32 m0, s22, 16384
    v_mfma_f32_16x16x32_bf16 v[40:43], a[122:125], v[132:135], v[40:43]
    v_cvt_pk_bf16_f32 v130, v12, v13
    v_mfma_f32_16x16x32_bf16 v[44:47], a[120:123], v[132:135], 0
    buffer_load_dwordx4 v190, s[8:11], s25 offen lds
    v_cvt_pk_bf16_f32 v129, v10, v11
    v_mfma_f32_16x16x32_bf16 v[44:47], a[116:119], v[132:135], v[44:47]
    v_cvt_pk_bf16_f32 v128, v8, v9
    v_cvt_pk_bf16_f32 v131, v14, v15
    v_mfma_f32_16x16x32_bf16 v[8:11], a[118:121], v[136:139], 0
    v_cvt_pk_bf16_f32 v133, v42, v43
    v_cvt_pk_bf16_f32 v132, v40, v41
    v_mfma_f32_16x16x32_bf16 v[8:11], a[122:125], v[136:139], v[8:11]
    s_nop 1
    v_cvt_pk_bf16_f32 v135, v46, v47
    v_mfma_f32_16x16x32_bf16 v[12:15], a[120:123], v[136:139], 0
    s_waitcnt vmcnt(11)
    s_barrier
    v_mfma_f32_16x16x32_bf16 v[12:15], a[116:119], v[136:139], v[12:15]
    ds_read_b128 v[240:243], v212 offset:0
    buffer_load_dwordx4 v191, s[8:11], s25 offen offset:1024 lds
    v_mfma_f32_16x16x32_bf16 v[40:43], a[118:121], v[140:143], 0
    ds_read_b128 v[244:247], v212 offset:128
    v_cvt_pk_bf16_f32 v137, v10, v11
    v_mfma_f32_16x16x32_bf16 v[40:43], a[122:125], v[140:143], v[40:43]
    ds_read_b64_tr_b16 a[190:191], v187 offset:4096
    v_cvt_pk_bf16_f32 v134, v44, v45
    v_cvt_pk_bf16_f32 v136, v8, v9
    v_cvt_pk_bf16_f32 v139, v14, v15
    v_mfma_f32_16x16x32_bf16 v[44:47], a[120:123], v[140:143], 0
    ds_read_b64_tr_b16 a[180:181], v185 offset:0
    v_cvt_pk_bf16_f32 v138, v12, v13
    v_mfma_f32_16x16x32_bf16 v[44:47], a[116:119], v[140:143], v[44:47]
    s_add_u32 m0, s27, 4096
    ds_read_b64_tr_b16 a[172:173], v183 offset:0
    v_cvt_pk_bf16_f32 v140, v40, v41
    v_mfma_f32_16x16x32_bf16 v[100:103], a[232:235], v[128:131], 0
    buffer_load_dwordx4 v200, s[12:15], s44 offen nt lds
    v_mfma_f32_16x16x32_bf16 v[100:103], a[236:239], v[132:135], v[100:103]
    ds_read_b64_tr_b16 a[174:175], v183 offset:4096
    v_cvt_pk_bf16_f32 v141, v42, v43
    v_cvt_pk_bf16_f32 v143, v46, v47
    v_cvt_pk_bf16_f32 v142, v44, v45
    v_mfma_f32_16x16x32_bf16 v[100:103], a[240:243], v[136:139], v[100:103]
    s_waitcnt lgkmcnt(3)
    v_and_b32 v246, 0x7fff7fff, v246
    v_and_b32 v241, 0x7fff7fff, v241
    v_mfma_f32_16x16x32_bf16 v[100:103], a[244:247], v[140:143], v[100:103]
    s_add_u32 s24, s24, 8192
    ds_read_b64_tr_b16 a[170:171], v182 offset:4096
    v_and_b32 v240, 0x7fff7fff, v240
    v_and_b32 v243, 0x7fff7fff, v243
    v_and_b32 v245, 0x7fff7fff, v245
    v_and_b32 v242, 0x7fff7fff, v242
    v_and_b32 v244, 0x7fff7fff, v244
    v_pk_max_u16 v240, v240, v244
    v_add_f32 v100, 0x4d400000, v100
    v_and_b32 v247, 0x7fff7fff, v247
    v_sub_f32 v100, 0x4d400000, v100
    v_add_f32 v103, 0xc1500000, v100
    v_add_f32 v102, 0xc1500000, v100
    v_pk_max_u16 v241, v241, v245
    v_pk_max_u16 v243, v243, v247
    v_pk_max_u16 v240, v240, v241
    v_add_f32 v101, 0xc1500000, v100
    v_pk_max_u16 v242, v242, v246
    v_add_f32 v100, 0xc1500000, v100
    v_pk_max_u16 v242, v242, v243
    v_pk_max_u16 v240, v240, v242
    v_mfma_f32_16x16x32_bf16 v[12:15], a[144:147], v[128:131], v[100:103]
    v_lshlrev_b32 v241, 16, v240
    v_mfma_f32_16x16x32_bf16 v[12:15], a[148:151], v[132:135], v[12:15]
    s_add_u32 s25, s25, 8192
    ds_read_b128 a[148:151], v177 offset:20480
    v_mfma_f32_16x16x32_bf16 v[12:15], a[152:155], v[136:139], v[12:15]
    v_max_u32 v240, v240, v241
    v_mfma_f32_16x16x32_bf16 v[12:15], a[156:159], v[140:143], v[12:15]
    ds_read_b128 a[156:159], v179 offset:20480
    v_min_u32 v240, 0x70000000, v240
    v_mfma_f32_16x16x32_bf16 v[8:11], a[140:143], v[140:143], v[100:103]
    ds_read_b64_tr_b16 a[184:185], v186 offset:0
    ds_read_b64_tr_b16 a[188:189], v187 offset:0
    v_mfma_f32_16x16x32_bf16 v[8:11], a[136:139], v[136:139], v[8:11]
    ds_read_b128 a[136:139], v178 offset:16384
    buffer_load_dwordx4 v201, s[12:15], s44 offen offset:1024 nt lds
    v_mfma_f32_16x16x32_bf16 v[8:11], a[132:135], v[132:135], v[8:11]
    ds_read_b128 a[144:147], v176 offset:20480
    v_mul_f32 v240, 0x40800000, v240
    v_mfma_f32_16x16x32_bf16 v[8:11], a[128:131], v[128:131], v[8:11]
    ds_read_b128 a[132:135], v177 offset:16384
    v_exp_f32 v12, v12
    v_mfma_f32_16x16x32_bf16 v[44:47], a[208:211], v[128:131], v[100:103]
    ds_read_b128 a[140:143], v179 offset:16384
    v_cvt_pk_bf16_f32 v64, v0, v1
    v_mfma_f32_16x16x32_bf16 v[44:47], a[212:215], v[132:135], v[44:47]
    v_exp_f32 v15, v15
    v_cvt_pk_bf16_f32 v215, v240, v240
    v_mfma_f32_16x16x32_bf16 v[44:47], a[216:219], v[136:139], v[44:47]
    v_exp_f32 v13, v13
    v_mfma_f32_16x16x32_bf16 v[44:47], a[220:223], v[140:143], v[44:47]
    ds_read_b64_tr_b16 a[182:183], v185 offset:4096
    v_exp_f32 v10, v10
    v_mfma_f32_16x16x32_bf16 v[40:43], a[204:207], v[140:143], v[100:103]
    ds_read_b128 a[152:155], v178 offset:20480
    v_cvt_pk_bf16_f32 v213, v240, v240
    v_mfma_f32_16x16x32_bf16 v[40:43], a[200:203], v[136:139], v[40:43]
    v_exp_f32 v14, v14
    v_mfma_f32_16x16x32_bf16 v[40:43], a[196:199], v[132:135], v[40:43]
    ds_read_b128 a[128:131], v176 offset:16384
    v_cvt_pk_bf16_f32 v70, v12, v13
    v_cvt_pk_bf16_f32 v71, v14, v15
    v_exp_f32 v8, v8
    v_exp_f32 v9, v9
    v_mfma_f32_16x16x32_bf16 v[40:43], a[192:195], v[128:131], v[40:43]
    ds_read_b64_tr_b16 a[160:161], v180 offset:0
    v_exp_f32 v11, v11
    s_waitcnt lgkmcnt(2)
    v_mfma_f32_16x16x32_bf16 v[4:7], a[144:147], v[112:115], v[96:99]
    ds_read_b64_tr_b16 a[186:187], v186 offset:4096
    buffer_load_dwordx4 v202, s[12:15], s44 offen offset:2048 nt lds
    v_mfma_f32_16x16x32_bf16 v[4:7], a[148:151], v[116:119], v[4:7]
    ds_read_b64_tr_b16 a[176:177], v184 offset:0
    v_mfma_f32_16x16x32_bf16 v[4:7], a[152:155], v[120:123], v[4:7]
    ds_read_b64_tr_b16 a[164:165], v181 offset:0
    v_cvt_pk_bf16_f32 v69, v10, v11
    v_mfma_f32_16x16x32_bf16 v[4:7], a[156:159], v[124:127], v[4:7]
    v_exp_f32 v43, v43
    v_mfma_f32_16x16x32_bf16 v[0:3], a[140:143], v[124:127], v[96:99]
    ds_read_b64_tr_b16 a[162:163], v180 offset:4096
    v_mfma_f32_16x16x32_bf16 v[0:3], a[136:139], v[120:123], v[0:3]
    v_cvt_pk_bf16_f32 v214, v240, v240
    v_cvt_pk_bf16_f32 v68, v8, v9
    v_mfma_f32_16x16x32_bf16 v[0:3], a[132:135], v[116:119], v[0:3]
    v_exp_f32 v42, v42
    s_waitcnt lgkmcnt(2)
    v_mfma_f32_16x16x32_bf16 v[0:3], a[128:131], v[112:115], v[0:3]
    ds_read_b64_tr_b16 a[178:179], v184 offset:4096
    v_exp_f32 v47, v47
    v_smfmac_f32_16x16x64_bf16 a[224:227], v[192:195], v[64:71], v196
    ds_read_b64_tr_b16 a[168:169], v182 offset:0
    v_exp_f32 v5, v5
    v_mfma_f32_16x16x32_bf16 v[12:15], a[156:159], v[140:143], v[100:103]
    v_exp_f32 v41, v41
    v_mfma_f32_16x16x32_bf16 v[12:15], a[152:155], v[136:139], v[12:15]
    v_cvt_pk_bf16_f32 v212, v240, v240
    v_exp_f32 v40, v40
    v_exp_f32 v46, v46
    v_mfma_f32_16x16x32_bf16 v[12:15], a[148:151], v[132:135], v[12:15]
    v_exp_f32 v1, v1
    v_exp_f32 v6, v6
    v_mfma_f32_16x16x32_bf16 v[12:15], a[144:147], v[128:131], v[12:15]
    s_waitcnt vmcnt(11)
    ds_read_b128 v[144:147], v204 offset:0
    v_mfma_f32_16x16x32_bf16 v[8:11], a[128:131], v[128:131], v[100:103]
    buffer_load_dwordx4 v203, s[12:15], s44 offen offset:3072 nt lds
    s_add_u32 m0, s21, 40960
    v_mfma_f32_16x16x32_bf16 v[8:11], a[132:135], v[132:135], v[8:11]
    ds_read_b128 v[148:151], v205 offset:0
    v_exp_f32 v3, v3
    v_mfma_f32_16x16x32_bf16 v[8:11], a[136:139], v[136:139], v[8:11]
    v_exp_f32 v12, v12
    v_cvt_pk_bf16_f32 v87, v46, v47
    v_mfma_f32_16x16x32_bf16 v[8:11], a[140:143], v[140:143], v[8:11]
    v_exp_f32 v45, v45
    s_waitcnt lgkmcnt(1)
    v_mfma_f32_16x16x32_bf16 v[16:19], a[118:121], v[144:147], 0
    ds_read_b128 v[152:155], v206 offset:0
    v_exp_f32 v15, v15
    v_mfma_f32_16x16x32_bf16 v[16:19], a[122:125], v[144:147], v[16:19]
    v_exp_f32 v0, v0
    v_mfma_f32_16x16x32_bf16 v[20:23], a[120:123], v[144:147], 0
    v_exp_f32 v4, v4
    v_mfma_f32_16x16x32_bf16 v[20:23], a[116:119], v[144:147], v[20:23]
    v_cvt_pk_bf16_f32 v84, v40, v41
    s_waitcnt lgkmcnt(1)
    v_mfma_f32_16x16x32_bf16 v[48:51], a[118:121], v[148:151], 0
    ds_read_b128 v[156:159], v207 offset:0
    v_cvt_pk_bf16_f32 v145, v18, v19
    v_mfma_f32_16x16x32_bf16 v[48:51], a[122:125], v[148:151], v[48:51]
    ds_read_b64_tr_b16 a[166:167], v181 offset:4096
    v_exp_f32 v8, v8
    v_mfma_f32_16x16x32_bf16 v[52:55], a[120:123], v[148:151], 0
    buffer_load_dwordx4 v188, s[4:7], s24 offen lds
    v_mfma_f32_16x16x32_bf16 v[52:55], a[116:119], v[148:151], v[52:55]
    v_cvt_pk_bf16_f32 v144, v16, v17
    s_waitcnt lgkmcnt(2)
    v_mfma_f32_16x16x32_bf16 v[16:19], a[118:121], v[152:155], 0
    buffer_load_dwordx4 v189, s[4:7], s24 offen offset:1024 lds
    v_cvt_pk_bf16_f32 v147, v22, v23
    v_mfma_f32_16x16x32_bf16 v[16:19], a[122:125], v[152:155], v[16:19]
    s_add_u32 m0, s22, 24576
    v_cvt_pk_bf16_f32 v146, v20, v21
    v_cvt_pk_bf16_f32 v150, v52, v53
    v_mfma_f32_16x16x32_bf16 v[20:23], a[120:123], v[152:155], 0
    s_add_u32 s24, s24, 8192
    v_cvt_pk_bf16_f32 v148, v48, v49
    v_cvt_pk_bf16_f32 v149, v50, v51
    v_mfma_f32_16x16x32_bf16 v[20:23], a[116:119], v[152:155], v[20:23]
    v_cvt_pk_bf16_f32 v153, v18, v19
    s_waitcnt lgkmcnt(0)
    v_mfma_f32_16x16x32_bf16 v[48:51], a[118:121], v[156:159], 0
    v_exp_f32 v7, v7
    v_mfma_f32_16x16x32_bf16 v[48:51], a[122:125], v[156:159], v[48:51]
    v_cvt_pk_bf16_f32 v151, v54, v55
    v_cvt_pk_bf16_f32 v152, v16, v17
    v_mfma_f32_16x16x32_bf16 v[52:55], a[120:123], v[156:159], 0
    v_cvt_pk_bf16_f32 v154, v20, v21
    v_cvt_pk_bf16_f32 v85, v42, v43
    v_mfma_f32_16x16x32_bf16 v[52:55], a[116:119], v[156:159], v[52:55]
    s_nop 1
    v_cvt_pk_bf16_f32 v157, v50, v51
    v_mfma_f32_16x16x32_bf16 v[104:107], a[232:235], v[144:147], 0
    v_cvt_pk_bf16_f32 v155, v22, v23
    v_cvt_pk_bf16_f32 v156, v48, v49
    v_mfma_f32_16x16x32_bf16 v[104:107], a[236:239], v[148:151], v[104:107]
    s_nop 0
    v_cvt_pk_bf16_f32 v158, v52, v53
    v_cvt_pk_bf16_f32 v159, v54, v55
    v_mfma_f32_16x16x32_bf16 v[104:107], a[240:243], v[152:155], v[104:107]
    v_exp_f32 v13, v13
    v_mfma_f32_16x16x32_bf16 v[104:107], a[244:247], v[156:159], v[104:107]
    v_exp_f32 v11, v11
    v_mfma_f32_16x16x32_bf16 v[216:219], v[64:67], v[212:215], 0
    buffer_load_dwordx4 v190, s[8:11], s25 offen lds
    v_mfma_f32_16x16x32_bf16 a[32:35], v[68:71], v[212:215], 0
    v_exp_f32 v10, v10
    v_mfma_f32_16x16x32_bf16 a[0:3], v[64:67], v[212:215], 0
    s_nop 1
    v_add_f32 v104, 0x4d400000, v104
    v_sub_f32 v104, 0x4d400000, v104
    v_mfma_f32_16x16x32_bf16 a[28:31], v[64:67], a[188:191], a[0:3]
    v_add_f32 v105, 0xc1500000, v104
    v_add_f32 v107, 0xc1500000, v104
    v_mfma_f32_16x16x32_bf16 a[4:7], v[64:67], a[164:167], a[0:3]
    v_add_f32 v106, 0xc1500000, v104
    v_add_f32 v104, 0xc1500000, v104
    v_mfma_f32_16x16x32_bf16 a[12:15], v[64:67], a[172:175], a[0:3]
    v_exp_f32 v44, v44
    v_mfma_f32_16x16x32_bf16 v[48:51], a[192:195], v[144:147], v[104:107]
    s_waitcnt vmcnt(11)
    s_barrier
    v_mfma_f32_16x16x32_bf16 v[48:51], a[196:199], v[148:151], v[48:51]
    ds_read_b64_tr_b16 a[192:193], v180 offset:8192
    v_exp_f32 v2, v2
    v_mfma_f32_16x16x32_bf16 v[48:51], a[200:203], v[152:155], v[48:51]
    buffer_load_dwordx4 v191, s[8:11], s25 offen offset:1024 lds
    v_mfma_f32_16x16x32_bf16 v[48:51], a[204:207], v[156:159], v[48:51]
    v_cvt_pk_bf16_f32 v86, v44, v45
    v_mfma_f32_16x16x32_bf16 v[52:55], a[220:223], v[156:159], v[104:107]
    ds_read_b64_tr_b16 a[198:199], v181 offset:12288
    v_mfma_f32_16x16x32_bf16 v[52:55], a[216:219], v[152:155], v[52:55]
    ds_read_b64_tr_b16 a[202:203], v182 offset:12288
    v_mfma_f32_16x16x32_bf16 v[52:55], a[212:215], v[148:151], v[52:55]
    ds_read_b64_tr_b16 a[216:217], v186 offset:8192
    ds_read_b64_tr_b16 a[212:213], v185 offset:8192
    v_mfma_f32_16x16x32_bf16 v[52:55], a[208:211], v[144:147], v[52:55]
    ds_read_b64_tr_b16 a[210:211], v184 offset:12288
    ds_read_b64_tr_b16 a[194:195], v180 offset:12288
    v_mfma_f32_16x16x32_bf16 v[16:19], a[128:131], v[144:147], v[104:107]
    ds_read_b64_tr_b16 a[214:215], v185 offset:12288
    s_add_u32 m0, s21, 49152
    ds_read_b64_tr_b16 a[196:197], v181 offset:8192
    v_mfma_f32_16x16x32_bf16 v[16:19], a[132:135], v[148:151], v[16:19]
    ds_read_b64_tr_b16 a[200:201], v182 offset:8192
    v_exp_f32 v9, v9
    v_mfma_f32_16x16x32_bf16 v[16:19], a[136:139], v[152:155], v[16:19]
    ds_read_b64_tr_b16 a[208:209], v184 offset:8192
    v_mfma_f32_16x16x32_bf16 v[16:19], a[140:143], v[156:159], v[16:19]
    ds_read_b64_tr_b16 a[220:221], v187 offset:8192
    v_exp_f32 v55, v55
    v_mfma_f32_16x16x32_bf16 v[20:23], a[156:159], v[156:159], v[104:107]
    ds_read_b64_tr_b16 a[218:219], v186 offset:12288
    v_mfma_f32_16x16x32_bf16 v[20:23], a[152:155], v[152:155], v[20:23]
    buffer_load_dwordx4 v188, s[4:7], s24 offen lds
    ds_read_b128 a[128:131], v176 offset:24576
    v_mfma_f32_16x16x32_bf16 v[20:23], a[148:151], v[148:151], v[20:23]
    ds_read_b64_tr_b16 a[222:223], v187 offset:12288
    v_mfma_f32_16x16x32_bf16 v[20:23], a[144:147], v[144:147], v[20:23]
    ds_read_b128 a[148:151], v177 offset:28672
    v_exp_f32 v51, v51
    s_waitcnt lgkmcnt(5)
    v_mfma_f32_16x16x32_bf16 a[16:19], v[80:83], a[208:211], a[0:3]
    ds_read_b128 a[152:155], v178 offset:28672
    v_exp_f32 v14, v14
    v_mfma_f32_16x16x32_bf16 a[8:11], v[80:83], a[200:203], a[0:3]
    ds_read_b64_tr_b16 a[204:205], v183 offset:8192
    s_waitcnt lgkmcnt(5)
    v_mfma_f32_16x16x32_bf16 a[24:27], v[80:83], a[216:219], a[0:3]
    ds_read_b128 a[144:147], v176 offset:28672
    v_exp_f32 v48, v48
    v_mfma_f32_16x16x32_bf16 a[24:27], v[64:67], a[184:187], a[24:27]
    v_exp_f32 v22, v22
    v_mfma_f32_16x16x32_bf16 a[16:19], v[64:67], a[176:179], a[16:19]
    v_exp_f32 v18, v18
    v_mfma_f32_16x16x32_bf16 a[20:23], v[64:67], a[180:183], a[0:3]
    buffer_load_dwordx4 v189, s[4:7], s24 offen offset:1024 lds
    v_mfma_f32_16x16x32_bf16 a[20:23], v[80:83], a[212:215], a[20:23]
    ds_read_b128 a[156:159], v179 offset:28672
    v_exp_f32 v23, v23
    v_mfma_f32_16x16x32_bf16 a[0:3], v[80:83], a[192:195], a[0:3]
    v_exp_f32 v21, v21
    v_mfma_f32_16x16x32_bf16 a[0:3], v[64:67], a[160:163], a[0:3]
    ds_read_b64_tr_b16 a[206:207], v183 offset:12288
    v_mfma_f32_16x16x32_bf16 a[8:11], v[64:67], a[168:171], a[8:11]
    ds_read_b128 a[132:135], v177 offset:24576
    v_exp_f32 v54, v54
    v_mfma_f32_16x16x32_bf16 a[40:43], v[68:71], a[168:171], a[32:35]
    v_exp_f32 v50, v50
    v_mfma_f32_16x16x32_bf16 a[40:43], v[84:87], a[200:203], a[40:43]
    v_exp_f32 v53, v53
    v_mfma_f32_16x16x32_bf16 a[36:39], v[84:87], a[196:199], a[32:35]
    s_add_u32 m0, s22, 32768
    v_cvt_pk_bf16_f32 v91, v54, v55
    v_cvt_pk_bf16_f32 v64, v0, v1
    v_mfma_f32_16x16x32_bf16 a[52:55], v[84:87], a[212:215], a[32:35]
    v_exp_f32 v49, v49
    v_mfma_f32_16x16x32_bf16 a[52:55], v[68:71], a[180:183], a[52:55]
    v_mfma_f32_16x16x32_bf16 a[56:59], v[68:71], a[184:187], a[32:35]
    ds_read_b128 a[136:139], v178 offset:24576
    v_exp_f32 v16, v16
    v_mfma_f32_16x16x32_bf16 v[220:223], v[68:71], v[212:215], 0
    v_exp_f32 v20, v20
    v_mfma_f32_16x16x32_bf16 a[48:51], v[68:71], a[176:179], a[32:35]
    s_waitcnt lgkmcnt(1)
    v_mfma_f32_16x16x32_bf16 v[36:39], a[156:159], v[124:127], v[96:99]
    s_add_u32 s24, s24, 8192
    v_cvt_pk_bf16_f32 v75, v22, v23
    v_mfma_f32_16x16x32_bf16 v[36:39], a[152:155], v[120:123], v[36:39]
    v_exp_f32 v52, v52
    v_mfma_f32_16x16x32_bf16 v[36:39], a[148:151], v[116:119], v[36:39]
    v_cvt_pk_bf16_f32 v88, v48, v49
    v_mfma_f32_16x16x32_bf16 v[36:39], a[144:147], v[112:115], v[36:39]
    v_exp_f32 v17, v17
    s_add_u32 s25, s25, 8192
    v_mfma_f32_16x16x32_bf16 v[32:35], a[128:131], v[112:115], v[96:99]
    v_mfma_f32_16x16x32_bf16 v[32:35], a[132:135], v[116:119], v[32:35]
    v_cvt_pk_bf16_f32 v74, v20, v21
    s_waitcnt lgkmcnt(0)
    v_mfma_f32_16x16x32_bf16 v[32:35], a[136:139], v[120:123], v[32:35]
    s_nop 0
    v_exp_f32 v37, v37
    v_mfma_f32_16x16x32_bf16 a[60:63], v[84:87], a[220:223], a[32:35]
    v_cvt_pk_bf16_f32 v89, v50, v51
    v_cvt_pk_bf16_f32 v72, v16, v17
    v_mfma_f32_16x16x32_bf16 a[60:63], v[68:71], a[188:191], a[60:63]
    v_exp_f32 v36, v36
    v_mfma_f32_16x16x32_bf16 a[36:39], v[68:71], a[164:167], a[36:39]
    v_exp_f32 v19, v19
    v_smfmac_f32_16x16x64_bf16 a[224:227], v[192:195], v[80:87], v196
    v_exp_f32 v38, v38
    v_mfma_f32_16x16x32_bf16 a[4:7], v[80:83], a[196:199], a[4:7]
    v_exp_f32 v39, v39
    v_mfma_f32_16x16x32_bf16 a[12:15], v[80:83], a[204:207], a[12:15]
    s_waitcnt vmcnt(6)
    ds_read_b128 v[160:163], v204 offset:4096
    v_mfma_f32_16x16x32_bf16 a[44:47], v[84:87], a[204:207], a[32:35]
    v_cvt_pk_bf16_f32 v65, v2, v3
    v_mfma_f32_16x16x32_bf16 a[44:47], v[68:71], a[172:175], a[44:47]
    ds_read_b128 v[164:167], v205 offset:4096
    v_cvt_pk_bf16_f32 v90, v52, v53
    v_mfma_f32_16x16x32_bf16 a[32:35], v[68:71], a[160:163], a[32:35]
    ds_read_b128 v[168:171], v206 offset:4096
    v_cvt_pk_bf16_f32 v70, v12, v13
    v_mfma_f32_16x16x32_bf16 v[52:55], a[156:159], v[156:159], v[104:107]
    v_cvt_pk_bf16_f32 v67, v6, v7
    v_smfmac_f32_16x16x64_bf16 a[228:231], v[192:195], v[88:95], v196
    s_waitcnt lgkmcnt(2)
    v_mfma_f32_16x16x32_bf16 v[28:31], a[120:123], v[160:163], 0
    v_mfma_f32_16x16x32_bf16 v[28:31], a[116:119], v[160:163], v[28:31]
    ds_read_b128 v[172:175], v207 offset:4096
    s_waitcnt lgkmcnt(2)
    v_mfma_f32_16x16x32_bf16 v[56:59], a[118:121], v[164:167], 0
    ds_read_b128 a[140:143], v179 offset:24576
    v_cvt_pk_bf16_f32 v69, v10, v11
    v_mfma_f32_16x16x32_bf16 v[56:59], a[122:125], v[164:167], v[56:59]
    v_cvt_pk_bf16_f32 v73, v18, v19
    v_mfma_f32_16x16x32_bf16 v[60:63], a[120:123], v[164:167], 0
    v_cvt_pk_bf16_f32 v71, v14, v15
    v_mfma_f32_16x16x32_bf16 v[60:63], a[116:119], v[164:167], v[60:63]
    v_cvt_pk_bf16_f32 v66, v4, v5
    v_mfma_f32_16x16x32_bf16 v[44:47], a[144:147], v[128:131], v[100:103]
    s_nop 1
    v_cvt_pk_bf16_f32 v164, v56, v57
    v_mfma_f32_16x16x32_bf16 a[28:31], v[80:83], a[220:223], a[28:31]
    v_cvt_pk_bf16_f32 v165, v58, v59
    s_waitcnt lgkmcnt(0)
    v_mfma_f32_16x16x32_bf16 v[56:59], a[118:121], v[172:175], 0
    s_waitcnt vmcnt(10)
    s_barrier
    v_mfma_f32_16x16x32_bf16 v[24:27], a[118:121], v[160:163], 0
    buffer_load_dwordx4 v190, s[8:11], s25 offen lds
    v_cvt_pk_bf16_f32 v166, v60, v61
    v_mfma_f32_16x16x32_bf16 v[24:27], a[122:125], v[160:163], v[24:27]
    v_cvt_pk_bf16_f32 v167, v62, v63
    v_mfma_f32_16x16x32_bf16 v[56:59], a[122:125], v[172:175], v[56:59]
    buffer_load_dwordx4 v191, s[8:11], s25 offen offset:1024 lds
    v_cvt_pk_bf16_f32 v162, v28, v29
    v_mfma_f32_16x16x32_bf16 v[60:63], a[120:123], v[172:175], 0
    ds_read_b64_tr_b16 a[178:179], v184 offset:20480
    v_cvt_pk_bf16_f32 v163, v30, v31
    v_mfma_f32_16x16x32_bf16 v[60:63], a[116:119], v[172:175], v[60:63]
    s_add_u32 s25, s25, 8192
    ds_read_b64_tr_b16 a[186:187], v186 offset:20480
    s_add_u32 m0, s21, 57344
    v_mfma_f32_16x16x32_bf16 v[28:31], a[120:123], v[168:171], 0
    ds_read_b64_tr_b16 a[188:189], v187 offset:16384
    v_cvt_pk_bf16_f32 v160, v24, v25
    v_mfma_f32_16x16x32_bf16 v[28:31], a[116:119], v[168:171], v[28:31]
    ds_read_b64_tr_b16 a[184:185], v186 offset:16384
    v_cvt_pk_bf16_f32 v161, v26, v27
    v_mfma_f32_16x16x32_bf16 v[24:27], a[118:121], v[168:171], 0
    ds_read_b64_tr_b16 a[182:183], v185 offset:20480
    buffer_load_dwordx4 v188, s[4:7], s24 offen lds
    v_mfma_f32_16x16x32_bf16 v[24:27], a[122:125], v[168:171], v[24:27]
    v_cvt_pk_bf16_f32 v172, v56, v57
    v_mfma_f32_16x16x32_bf16 v[48:51], a[128:131], v[144:147], v[104:107]
    ds_read_b64_tr_b16 a[170:171], v182 offset:20480
    v_cvt_pk_bf16_f32 v173, v58, v59
    v_mfma_f32_16x16x32_bf16 v[48:51], a[132:135], v[148:151], v[48:51]
    buffer_load_dwordx4 v189, s[4:7], s24 offen offset:1024 lds
    v_cvt_pk_bf16_f32 v171, v30, v31
    v_mfma_f32_16x16x32_bf16 v[48:51], a[136:139], v[152:155], v[48:51]
    s_add_u32 m0, s22, 40960
    v_cvt_pk_bf16_f32 v174, v60, v61
    v_mfma_f32_16x16x32_bf16 v[48:51], a[140:143], v[156:159], v[48:51]
    ds_read_b64_tr_b16 a[176:177], v184 offset:16384
    v_cvt_pk_bf16_f32 v170, v28, v29
    v_mfma_f32_16x16x32_bf16 v[44:47], a[148:151], v[132:135], v[44:47]
    buffer_load_dwordx4 v190, s[8:11], s25 offen lds
    v_cvt_pk_bf16_f32 v169, v26, v27
    v_mfma_f32_16x16x32_bf16 v[44:47], a[152:155], v[136:139], v[44:47]
    s_add_u32 s24, s24, 8192
    ds_read_b64_tr_b16 a[160:161], v180 offset:16384
    v_mfma_f32_16x16x32_bf16 v[44:47], a[156:159], v[140:143], v[44:47]
    v_cvt_pk_bf16_f32 v168, v24, v25
    v_mfma_f32_16x16x32_bf16 v[108:111], a[232:235], v[160:163], 0
    buffer_load_dwordx4 v191, s[8:11], s25 offen offset:1024 lds
    v_cvt_pk_bf16_f32 v175, v62, v63
    v_mfma_f32_16x16x32_bf16 v[108:111], a[236:239], v[164:167], v[108:111]
    v_mfma_f32_16x16x32_bf16 v[108:111], a[240:243], v[168:171], v[108:111]
    v_cvt_pk_bf16_f32 v82, v36, v37
    v_mfma_f32_16x16x32_bf16 v[108:111], a[244:247], v[172:175], v[108:111]
    ds_read_b64_tr_b16 a[172:173], v183 offset:16384
    v_cvt_pk_bf16_f32 v68, v8, v9
    v_mfma_f32_16x16x32_bf16 a[32:35], v[84:87], a[192:195], a[32:35]
    ds_read_b64_tr_b16 a[164:165], v181 offset:16384
    s_add_u32 m0, s21, 0
    s_add_u32 s25, s25, 8192
    v_mfma_f32_16x16x32_bf16 v[32:35], a[140:143], v[124:127], v[32:35]
    buffer_load_dwordx4 v188, s[4:7], s24 offen lds
    v_add_f32 v108, 0x4d400000, v108
    v_mfma_f32_16x16x32_bf16 v[40:43], a[140:143], v[140:143], v[100:103]
    ds_read_b64_tr_b16 a[190:191], v187 offset:20480
    v_sub_f32 v108, 0x4d400000, v108
    v_mfma_f32_16x16x32_bf16 v[40:43], a[136:139], v[136:139], v[40:43]
    v_add_f32 v109, 0xc1500000, v108
    v_mfma_f32_16x16x32_bf16 v[40:43], a[132:135], v[132:135], v[40:43]
    buffer_load_dwordx4 v189, s[4:7], s24 offen offset:1024 lds
    ds_read_b64_tr_b16 a[166:167], v181 offset:20480
    v_mfma_f32_16x16x32_bf16 v[40:43], a[128:131], v[128:131], v[40:43]
    s_add_u32 m0, s22, 49152
    ds_read_b64_tr_b16 a[174:175], v183 offset:20480
    v_add_f32 v110, 0xc1500000, v108
    v_mfma_f32_16x16x32_bf16 v[52:55], a[152:155], v[152:155], v[52:55]
    ds_read_b64_tr_b16 a[162:163], v180 offset:20480
    v_add_f32 v111, 0xc1500000, v108
    v_mfma_f32_16x16x32_bf16 v[52:55], a[148:151], v[148:151], v[52:55]
    v_add_f32 v108, 0xc1500000, v108
    v_mfma_f32_16x16x32_bf16 v[52:55], a[144:147], v[144:147], v[52:55]
    v_exp_f32 v45, v45
    v_mfma_f32_16x16x32_bf16 v[60:63], a[144:147], v[160:163], v[108:111]
    ds_read_b64_tr_b16 a[168:169], v182 offset:16384
    v_mfma_f32_16x16x32_bf16 v[60:63], a[148:151], v[164:167], v[60:63]
    ds_read_b128 a[144:147], v176 offset:36864
    v_exp_f32 v32, v32
    v_mfma_f32_16x16x32_bf16 v[60:63], a[152:155], v[168:171], v[60:63]
    v_exp_f32 v42, v42
    v_mfma_f32_16x16x32_bf16 v[60:63], a[156:159], v[172:175], v[60:63]
    s_add_u32 s24, s24, 8192
    v_exp_f32 v46, v46
    v_mfma_f32_16x16x32_bf16 v[56:59], a[140:143], v[172:175], v[108:111]
    v_exp_f32 v33, v33
    v_mfma_f32_16x16x32_bf16 v[56:59], a[136:139], v[168:171], v[56:59]
    v_cvt_pk_bf16_f32 v83, v38, v39
    v_mfma_f32_16x16x32_bf16 v[56:59], a[132:135], v[164:167], v[56:59]
    ds_read_b128 a[136:139], v178 offset:32768
    v_exp_f32 v55, v55
    v_mfma_f32_16x16x32_bf16 v[56:59], a[128:131], v[160:163], v[56:59]
    v_mfma_f32_16x16x32_bf16 a[64:67], v[88:91], v[212:215], 0
    v_exp_f32 v40, v40
    v_mfma_f32_16x16x32_bf16 a[68:71], v[88:91], a[196:199], a[64:67]
    ds_read_b128 a[140:143], v179 offset:32768
    s_waitcnt lgkmcnt(2)
    v_mfma_f32_16x16x32_bf16 a[68:71], v[72:75], a[164:167], a[68:71]
    buffer_load_dwordx4 v190, s[8:11], s25 offen lds
    ds_read_b128 a[132:135], v177 offset:32768
    v_mfma_f32_16x16x32_bf16 a[88:91], v[72:75], a[184:187], a[64:67]
    buffer_load_dwordx4 v191, s[8:11], s25 offen offset:1024 lds
    ds_read_b64_tr_b16 a[180:181], v185 offset:16384
    v_mfma_f32_16x16x32_bf16 a[88:91], v[88:91], a[216:219], a[88:91]
    ds_read_b128 a[128:131], v176 offset:32768
    v_exp_f32 v53, v53
    v_mfma_f32_16x16x32_bf16 v[224:227], v[88:91], v[212:215], 0
    v_exp_f32 v50, v50
    v_mfma_f32_16x16x32_bf16 a[76:79], v[88:91], a[204:207], a[64:67]
    v_exp_f32 v60, v60
    v_mfma_f32_16x16x32_bf16 a[76:79], v[72:75], a[172:175], a[76:79]
    v_exp_f32 v41, v41
    v_mfma_f32_16x16x32_bf16 a[56:59], v[84:87], a[216:219], a[56:59]
    v_exp_f32 v57, v57
    v_mfma_f32_16x16x32_bf16 a[48:51], v[84:87], a[208:211], a[48:51]
    s_waitcnt lgkmcnt(0)
    v_mfma_f32_16x16x32_bf16 v[16:19], a[128:131], v[144:147], v[104:107]
    s_add_u32 m0, s21, 8192
    v_exp_f32 v59, v59
    v_mfma_f32_16x16x32_bf16 v[16:19], a[132:135], v[148:151], v[16:19]
    v_exp_f32 v34, v34
    v_mfma_f32_16x16x32_bf16 v[16:19], a[136:139], v[152:155], v[16:19]
    v_exp_f32 v56, v56
    v_mfma_f32_16x16x32_bf16 v[16:19], a[140:143], v[156:159], v[16:19]
    ds_read_b128 a[152:155], v178 offset:36864
    v_cvt_pk_bf16_f32 v80, v32, v33
    v_mfma_f32_16x16x32_bf16 v[8:11], a[140:143], v[140:143], v[100:103]
    v_exp_f32 v58, v58
    v_mfma_f32_16x16x32_bf16 v[8:11], a[136:139], v[136:139], v[8:11]
    buffer_load_dwordx4 v188, s[4:7], s24 offen lds
    v_mfma_f32_16x16x32_bf16 v[0:3], a[128:131], v[112:115], v[96:99]
    ds_read_b128 a[156:159], v179 offset:36864
    v_exp_f32 v49, v49
    v_mfma_f32_16x16x32_bf16 v[0:3], a[132:135], v[116:119], v[0:3]
    v_cvt_pk_bf16_f32 v93, v58, v59
    v_mfma_f32_16x16x32_bf16 v[0:3], a[136:139], v[120:123], v[0:3]
    ds_read_b128 a[148:151], v177 offset:36864
    v_exp_f32 v43, v43
    v_mfma_f32_16x16x32_bf16 v[0:3], a[140:143], v[124:127], v[0:3]
    v_exp_f32 v44, v44
    v_mfma_f32_16x16x32_bf16 a[8:11], v[64:67], a[168:171], a[8:11]
    v_exp_f32 v61, v61
    v_mfma_f32_16x16x32_bf16 a[72:75], v[72:75], a[168:171], a[64:67]
    v_exp_f32 v18, v18
    v_mfma_f32_16x16x32_bf16 a[72:75], v[88:91], a[200:203], a[72:75]
    v_cvt_pk_bf16_f32 v85, v42, v43
    v_mfma_f32_16x16x32_bf16 v[28:31], a[144:147], v[160:163], v[108:111]
    buffer_load_dwordx4 v189, s[4:7], s24 offen offset:1024 lds
    s_waitcnt lgkmcnt(0)
    v_mfma_f32_16x16x32_bf16 v[28:31], a[148:151], v[164:167], v[28:31]
    v_exp_f32 v0, v0
    v_mfma_f32_16x16x32_bf16 v[28:31], a[152:155], v[168:171], v[28:31]
    s_add_u32 s24, s24, 8192
    v_exp_f32 v16, v16
    v_mfma_f32_16x16x32_bf16 v[28:31], a[156:159], v[172:175], v[28:31]
    v_exp_f32 v47, v47
    v_mfma_f32_16x16x32_bf16 v[4:7], a[156:159], v[124:127], v[96:99]
    v_exp_f32 v62, v62
    v_mfma_f32_16x16x32_bf16 v[4:7], a[152:155], v[120:123], v[4:7]
    s_add_u32 m0, s22, 57344
    v_exp_f32 v35, v35
    v_mfma_f32_16x16x32_bf16 v[4:7], a[148:151], v[116:119], v[4:7]
    s_nop 0
    v_exp_f32 v30, v30
    v_mfma_f32_16x16x32_bf16 a[84:87], v[88:91], a[212:215], a[64:67]
    v_exp_f32 v2, v2
    v_mfma_f32_16x16x32_bf16 a[84:87], v[72:75], a[180:183], a[84:87]
    v_cvt_pk_bf16_f32 v84, v40, v41
    v_mfma_f32_16x16x32_bf16 a[80:83], v[72:75], a[176:179], a[64:67]
    v_exp_f32 v48, v48
    v_mfma_f32_16x16x32_bf16 a[80:83], v[88:91], a[208:211], a[80:83]
    v_exp_f32 v17, v17
    v_mfma_f32_16x16x32_bf16 a[92:95], v[88:91], a[220:223], a[64:67]
    v_exp_f32 v28, v28
    v_mfma_f32_16x16x32_bf16 a[92:95], v[72:75], a[188:191], a[92:95]
    v_exp_f32 v3, v3
    v_mfma_f32_16x16x32_bf16 a[64:67], v[72:75], a[160:163], a[64:67]
    v_cvt_pk_bf16_f32 v86, v44, v45
    v_mfma_f32_16x16x32_bf16 a[64:67], v[88:91], a[192:195], a[64:67]
    s_add_u32 s25, s25, 8192
    v_exp_f32 v52, v52
    v_mfma_f32_16x16x32_bf16 v[24:27], a[140:143], v[172:175], v[108:111]
    buffer_load_dwordx4 v190, s[8:11], s25 offen lds
    v_mfma_f32_16x16x32_bf16 v[24:27], a[136:139], v[168:171], v[24:27]
    v_exp_f32 v29, v29
    v_mfma_f32_16x16x32_bf16 v[24:27], a[132:135], v[164:167], v[24:27]
    v_exp_f32 v51, v51
    v_mfma_f32_16x16x32_bf16 v[12:15], a[144:147], v[128:131], v[100:103]
    s_waitcnt vmcnt(11)
    s_barrier
    v_mfma_f32_16x16x32_bf16 v[12:15], a[148:151], v[132:135], v[12:15]
    ds_read_b128 a[140:143], v179 offset:40960
    v_cvt_pk_bf16_f32 v81, v34, v35
    v_mfma_f32_16x16x32_bf16 v[12:15], a[152:155], v[136:139], v[12:15]
    ds_read_b128 a[136:139], v178 offset:40960
    buffer_load_dwordx4 v191, s[8:11], s25 offen offset:1024 lds
    v_mfma_f32_16x16x32_bf16 v[12:15], a[156:159], v[140:143], v[12:15]
    ds_read_b64_tr_b16 a[196:197], v181 offset:24576
    s_add_u32 m0, s21, 16384
    ds_read_b64_tr_b16 a[214:215], v185 offset:28672
    v_mfma_f32_16x16x32_bf16 v[20:23], a[156:159], v[156:159], v[104:107]
    ds_read_b64_tr_b16 a[216:217], v186 offset:24576
    s_add_u32 s25, s25, 8192
    ds_read_b64_tr_b16 a[198:199], v181 offset:28672
    v_mfma_f32_16x16x32_bf16 v[20:23], a[152:155], v[152:155], v[20:23]
    ds_read_b64_tr_b16 a[204:205], v183 offset:24576
    ds_read_b64_tr_b16 a[208:209], v184 offset:24576
    v_mfma_f32_16x16x32_bf16 v[20:23], a[148:151], v[148:151], v[20:23]
    buffer_load_dwordx4 v188, s[4:7], s24 offen lds
    ds_read_b64_tr_b16 a[200:201], v182 offset:24576
    v_mfma_f32_16x16x32_bf16 v[20:23], a[144:147], v[144:147], v[20:23]
    ds_read_b64_tr_b16 a[206:207], v183 offset:28672
    ds_read_b64_tr_b16 a[212:213], v185 offset:24576
    v_mfma_f32_16x16x32_bf16 v[4:7], a[144:147], v[112:115], v[4:7]
    ds_read_b128 a[156:159], v179 offset:45056
    buffer_load_dwordx4 v189, s[4:7], s24 offen offset:1024 lds
    v_smfmac_f32_16x16x64_bf16 a[224:227], v[192:195], v[64:71], v196
    ds_read_b64_tr_b16 a[194:195], v180 offset:28672
    v_exp_f32 v54, v54
    v_mfma_f32_16x16x32_bf16 a[36:39], v[68:71], a[164:167], a[36:39]
    ds_read_b64_tr_b16 a[222:223], v187 offset:28672
    v_cvt_pk_bf16_f32 v87, v46, v47
    v_mfma_f32_16x16x32_bf16 a[44:47], v[68:71], a[172:175], a[44:47]
    v_cvt_pk_bf16_f32 v94, v60, v61
    v_mfma_f32_16x16x32_bf16 a[52:55], v[68:71], a[180:183], a[52:55]
    ds_read_b64_tr_b16 a[202:203], v182 offset:28672
    v_exp_f32 v31, v31
    v_mfma_f32_16x16x32_bf16 a[60:63], v[68:71], a[188:191], a[60:63]
    ds_read_b64_tr_b16 a[218:219], v186 offset:28672
    s_waitcnt lgkmcnt(4)
    v_mfma_f32_16x16x32_bf16 a[20:23], v[80:83], a[212:215], a[20:23]
    ds_read_b128 a[144:147], v176 offset:45056
    v_cvt_pk_bf16_f32 v91, v54, v55
    v_mfma_f32_16x16x32_bf16 a[12:15], v[80:83], a[204:207], a[12:15]
    ds_read_b64_tr_b16 a[192:193], v180 offset:24576
    s_add_u32 m0, s22, 0
    ds_read_b128 a[148:151], v177 offset:45056
    v_mfma_f32_16x16x32_bf16 a[12:15], v[64:67], a[172:175], a[12:15]
    buffer_load_dwordx4 v190, s[8:11], s25 offen lds
    ds_read_b128 a[152:155], v178 offset:45056
    v_mfma_f32_16x16x32_bf16 a[0:3], v[64:67], a[160:163], a[0:3]
    v_exp_f32 v63, v63
    v_mfma_f32_16x16x32_bf16 a[20:23], v[64:67], a[180:183], a[20:23]
    v_exp_f32 v20, v20
    v_mfma_f32_16x16x32_bf16 v[24:27], a[128:131], v[160:163], v[24:27]
    ds_read_b64_tr_b16 a[174:175], v183 offset:36864
    v_cvt_pk_bf16_f32 v88, v48, v49
    v_mfma_f32_16x16x32_bf16 v[8:11], a[132:135], v[132:135], v[8:11]
    v_exp_f32 v4, v4
    v_mfma_f32_16x16x32_bf16 v[8:11], a[128:131], v[128:131], v[8:11]
    ds_read_b64_tr_b16 a[210:211], v184 offset:28672
    s_waitcnt lgkmcnt(2)
    v_mfma_f32_16x16x32_bf16 v[44:47], a[144:147], v[128:131], v[100:103]
    ds_read_b64_tr_b16 a[220:221], v187 offset:24576
    v_exp_f32 v19, v19
    v_mfma_f32_16x16x32_bf16 v[44:47], a[148:151], v[132:135], v[44:47]
    ds_read_b128 a[128:131], v176 offset:40960
    v_cvt_pk_bf16_f32 v95, v62, v63
    v_mfma_f32_16x16x32_bf16 v[44:47], a[152:155], v[136:139], v[44:47]
    v_exp_f32 v22, v22
    v_mfma_f32_16x16x32_bf16 v[44:47], a[156:159], v[140:143], v[44:47]
    ds_read_b128 a[132:135], v177 offset:40960
    v_cvt_pk_bf16_f32 v89, v50, v51
    v_mfma_f32_16x16x32_bf16 v[36:39], a[156:159], v[124:127], v[96:99]
    buffer_load_dwordx4 v191, s[8:11], s25 offen offset:1024 lds
    v_mfma_f32_16x16x32_bf16 v[36:39], a[152:155], v[120:123], v[36:39]
    s_add_u32 s25, s25, 8192
    v_exp_f32 v7, v7
    v_mfma_f32_16x16x32_bf16 v[36:39], a[148:151], v[116:119], v[36:39]
    v_exp_f32 v12, v12
    v_mfma_f32_16x16x32_bf16 v[36:39], a[144:147], v[112:115], v[36:39]
    s_add_u32 m0, s21, 24576
    v_exp_f32 v26, v26
    v_mfma_f32_16x16x32_bf16 v[60:63], a[144:147], v[160:163], v[108:111]
    v_exp_f32 v27, v27
    v_mfma_f32_16x16x32_bf16 v[60:63], a[148:151], v[164:167], v[60:63]
    s_add_u32 s24, s24, 8192
    v_cvt_pk_bf16_f32 v92, v56, v57
    v_mfma_f32_16x16x32_bf16 v[60:63], a[152:155], v[168:171], v[60:63]
    buffer_load_dwordx4 v188, s[4:7], s24 offen lds
    v_mfma_f32_16x16x32_bf16 v[60:63], a[156:159], v[172:175], v[60:63]
    buffer_load_dwordx4 v189, s[4:7], s24 offen offset:1024 lds
    s_waitcnt lgkmcnt(0)
    v_mfma_f32_16x16x32_bf16 v[32:35], a[128:131], v[112:115], v[96:99]
    s_add_u32 m0, s22, 8192
    v_exp_f32 v24, v24
    v_mfma_f32_16x16x32_bf16 v[32:35], a[132:135], v[116:119], v[32:35]
    v_exp_f32 v1, v1
    v_mfma_f32_16x16x32_bf16 v[32:35], a[136:139], v[120:123], v[32:35]
    v_exp_f32 v21, v21
    v_mfma_f32_16x16x32_bf16 v[32:35], a[140:143], v[124:127], v[32:35]
    v_exp_f32 v11, v11
    v_smfmac_f32_16x16x64_bf16 a[228:231], v[192:195], v[72:79], v196
    v_exp_f32 v36, v36
    v_mfma_f32_16x16x32_bf16 a[4:7], v[80:83], a[196:199], a[4:7]
    s_add_u32 s24, s24, 8192
    v_exp_f32 v13, v13
    v_mfma_f32_16x16x32_bf16 a[36:39], v[84:87], a[196:199], a[36:39]
    v_exp_f32 v25, v25
    v_mfma_f32_16x16x32_bf16 a[48:51], v[84:87], a[208:211], a[48:51]
    v_exp_f32 v33, v33
    v_mfma_f32_16x16x32_bf16 a[48:51], v[68:71], a[176:179], a[48:51]
    v_exp_f32 v23, v23
    v_mfma_f32_16x16x32_bf16 a[16:19], v[64:67], a[176:179], a[16:19]
    v_exp_f32 v6, v6
    v_mfma_f32_16x16x32_bf16 a[16:19], v[80:83], a[208:211], a[16:19]
    v_cvt_pk_bf16_f32 v74, v20, v21
    v_mfma_f32_16x16x32_bf16 a[28:31], v[80:83], a[220:223], a[28:31]
    ds_read_b64_tr_b16 a[180:181], v185 offset:32768
    v_exp_f32 v14, v14
    v_mfma_f32_16x16x32_bf16 a[28:31], v[64:67], a[188:191], a[28:31]
    v_cvt_pk_bf16_f32 v72, v16, v17
    v_mfma_f32_16x16x32_bf16 a[4:7], v[64:67], a[164:167], a[4:7]
    buffer_load_dwordx4 v190, s[8:11], s25 offen lds
    v_mfma_f32_16x16x32_bf16 a[24:27], v[64:67], a[184:187], a[24:27]
    buffer_load_dwordx4 v191, s[8:11], s25 offen offset:1024 lds
    v_cvt_pk_bf16_f32 v90, v52, v53
    v_mfma_f32_16x16x32_bf16 a[24:27], v[80:83], a[216:219], a[24:27]
    v_cvt_pk_bf16_f32 v79, v30, v31
    v_mfma_f32_16x16x32_bf16 a[56:59], v[84:87], a[216:219], a[56:59]
    ds_read_b64_tr_b16 a[190:191], v187 offset:36864
    v_cvt_pk_bf16_f32 v73, v18, v19
    v_mfma_f32_16x16x32_bf16 a[56:59], v[68:71], a[184:187], a[56:59]
    ds_read_b64_tr_b16 a[164:165], v181 offset:32768
    v_exp_f32 v34, v34
    v_mfma_f32_16x16x32_bf16 v[52:55], a[156:159], v[156:159], v[104:107]
    s_add_u32 m0, s21, 32768
    v_exp_f32 v32, v32
    v_mfma_f32_16x16x32_bf16 v[52:55], a[152:155], v[152:155], v[52:55]
    v_exp_f32 v44, v44
    v_mfma_f32_16x16x32_bf16 v[52:55], a[148:151], v[148:151], v[52:55]
    ds_read_b128 a[156:159], v179 offset:53248
    v_cvt_pk_bf16_f32 v75, v22, v23
    v_mfma_f32_16x16x32_bf16 v[52:55], a[144:147], v[144:147], v[52:55]
    v_mfma_f32_16x16x32_bf16 a[84:87], v[88:91], a[212:215], a[84:87]
    ds_read_b128 a[152:155], v178 offset:53248
    v_exp_f32 v38, v38
    v_mfma_f32_16x16x32_bf16 a[76:79], v[88:91], a[204:207], a[76:79]
    v_exp_f32 v8, v8
    v_mfma_f32_16x16x32_bf16 a[44:47], v[84:87], a[204:207], a[44:47]
    s_add_u32 s25, s25, 8192
    v_exp_f32 v45, v45
    v_mfma_f32_16x16x32_bf16 a[52:55], v[84:87], a[212:215], a[52:55]
    v_exp_f32 v5, v5
    v_mfma_f32_16x16x32_bf16 a[60:63], v[84:87], a[220:223], a[60:63]
    v_cvt_pk_bf16_f32 v66, v4, v5
    v_mfma_f32_16x16x32_bf16 a[32:35], v[84:87], a[192:195], a[32:35]
    ds_read_b64_tr_b16 a[178:179], v184 offset:36864
    buffer_load_dwordx4 v188, s[4:7], s24 offen lds
    v_mfma_f32_16x16x32_bf16 a[40:43], v[84:87], a[200:203], a[40:43]
    ds_read_b64_tr_b16 a[186:187], v186 offset:36864
    v_exp_f32 v35, v35
    v_mfma_f32_16x16x32_bf16 a[40:43], v[68:71], a[168:171], a[40:43]
    v_cvt_pk_bf16_f32 v67, v6, v7
    v_mfma_f32_16x16x32_bf16 a[32:35], v[68:71], a[160:163], a[32:35]
    ds_read_b64_tr_b16 a[172:173], v183 offset:32768
    ds_read_b64_tr_b16 a[176:177], v184 offset:32768
    v_mfma_f32_16x16x32_bf16 v[40:43], a[140:143], v[140:143], v[100:103]
    buffer_load_dwordx4 v189, s[4:7], s24 offen offset:1024 lds
    v_mfma_f32_16x16x32_bf16 v[40:43], a[136:139], v[136:139], v[40:43]
    v_cvt_pk_bf16_f32 v76, v24, v25
    v_mfma_f32_16x16x32_bf16 v[40:43], a[132:135], v[132:135], v[40:43]
    ds_read_b64_tr_b16 a[182:183], v185 offset:36864
    ds_read_b128 a[148:151], v177 offset:53248
    v_mfma_f32_16x16x32_bf16 v[40:43], a[128:131], v[128:131], v[40:43]
    v_cvt_pk_bf16_f32 v77, v26, v27
    v_mfma_f32_16x16x32_bf16 v[48:51], a[128:131], v[144:147], v[104:107]
    s_add_u32 s24, s24, 8192
    ds_read_b64_tr_b16 a[166:167], v181 offset:36864
    v_mfma_f32_16x16x32_bf16 v[48:51], a[132:135], v[148:151], v[48:51]
    v_cvt_pk_bf16_f32 v78, v28, v29
    v_mfma_f32_16x16x32_bf16 v[48:51], a[136:139], v[152:155], v[48:51]
    s_add_u32 m0, s22, 16384
    ds_read_b64_tr_b16 a[170:171], v182 offset:36864
    v_mfma_f32_16x16x32_bf16 v[48:51], a[140:143], v[156:159], v[48:51]
    buffer_load_dwordx4 v190, s[8:11], s25 offen lds
    v_mfma_f32_16x16x32_bf16 v[56:59], a[140:143], v[172:175], v[108:111]
    ds_read_b64_tr_b16 a[188:189], v187 offset:32768
    v_mfma_f32_16x16x32_bf16 v[56:59], a[136:139], v[168:171], v[56:59]
    ds_read_b64_tr_b16 a[184:185], v186 offset:32768
    ds_read_b128 a[140:143], v179 offset:49152
    v_mfma_f32_16x16x32_bf16 v[56:59], a[132:135], v[164:167], v[56:59]
    ds_read_b64_tr_b16 a[162:163], v180 offset:36864
    v_mfma_f32_16x16x32_bf16 v[56:59], a[128:131], v[160:163], v[56:59]
    ds_read_b64_tr_b16 a[168:169], v182 offset:32768
    v_exp_f32 v42, v42
    v_mfma_f32_16x16x32_bf16 a[8:11], v[80:83], a[200:203], a[8:11]
    v_exp_f32 v10, v10
    v_mfma_f32_16x16x32_bf16 a[0:3], v[80:83], a[192:195], a[0:3]
    v_exp_f32 v43, v43
    v_smfmac_f32_16x16x64_bf16 a[228:231], v[192:195], v[88:95], v196
    v_cvt_pk_bf16_f32 v64, v0, v1
    v_smfmac_f32_16x16x64_bf16 a[228:231], v[192:195], v[72:79], v196
    ds_read_b64_tr_b16 a[160:161], v180 offset:32768
    v_cvt_pk_bf16_f32 v70, v12, v13
    v_smfmac_f32_16x16x64_bf16 a[224:227], v[192:195], v[80:87], v196
    v_mfma_f32_16x16x32_bf16 a[96:99], v[92:95], v[212:215], 0
    v_mfma_f32_16x16x32_bf16 a[112:115], v[92:95], a[208:211], a[96:99]
    ds_read_b128 a[128:131], v176 offset:49152
    v_exp_f32 v39, v39
    v_mfma_f32_16x16x32_bf16 a[68:71], v[88:91], a[196:199], a[68:71]
    s_waitcnt lgkmcnt(2)
    v_mfma_f32_16x16x32_bf16 a[68:71], v[72:75], a[164:167], a[68:71]
    ds_read_b128 a[132:135], v177 offset:49152
    v_mfma_f32_16x16x32_bf16 a[100:103], v[76:79], a[164:167], a[96:99]
    v_cvt_pk_bf16_f32 v86, v44, v45
    v_mfma_f32_16x16x32_bf16 a[124:127], v[76:79], a[188:191], a[96:99]
    v_exp_f32 v41, v41
    v_mfma_f32_16x16x32_bf16 a[124:127], v[92:95], a[220:223], a[124:127]
    v_cvt_pk_bf16_f32 v83, v38, v39
    v_mfma_f32_16x16x32_bf16 v[228:231], v[92:95], v[212:215], 0
    v_exp_f32 v46, v46
    v_mfma_f32_16x16x32_bf16 a[104:107], v[92:95], a[200:203], a[96:99]
    buffer_load_dwordx4 v191, s[8:11], s25 offen offset:1024 lds
    v_mfma_f32_16x16x32_bf16 a[104:107], v[76:79], a[168:171], a[104:107]
    v_exp_f32 v37, v37
    v_mfma_f32_16x16x32_bf16 a[72:75], v[72:75], a[168:171], a[72:75]
    v_mfma_f32_16x16x32_bf16 a[88:91], v[72:75], a[184:187], a[88:91]
    v_cvt_pk_bf16_f32 v69, v10, v11
    v_mfma_f32_16x16x32_bf16 a[88:91], v[88:91], a[216:219], a[88:91]
    v_exp_f32 v40, v40
    v_mfma_f32_16x16x32_bf16 a[120:123], v[92:95], a[216:219], a[96:99]
    s_add_u32 s25, s25, 8192
    v_exp_f32 v47, v47
    v_mfma_f32_16x16x32_bf16 a[120:123], v[76:79], a[184:187], a[120:123]
    ds_read_b128 a[136:139], v178 offset:49152
    v_mfma_f32_16x16x32_bf16 a[112:115], v[76:79], a[176:179], a[112:115]
    v_cvt_pk_bf16_f32 v82, v36, v37
    v_mfma_f32_16x16x32_bf16 a[80:83], v[72:75], a[176:179], a[80:83]
    v_mfma_f32_16x16x32_bf16 a[80:83], v[88:91], a[208:211], a[80:83]
    v_cvt_pk_bf16_f32 v84, v40, v41
    v_mfma_f32_16x16x32_bf16 a[72:75], v[88:91], a[200:203], a[72:75]
    v_exp_f32 v15, v15
    v_mfma_f32_16x16x32_bf16 a[92:95], v[88:91], a[220:223], a[92:95]
    v_exp_f32 v9, v9
    v_mfma_f32_16x16x32_bf16 a[92:95], v[72:75], a[188:191], a[92:95]
    ds_read_b128 a[144:147], v176 offset:53248
    v_mfma_f32_16x16x32_bf16 a[76:79], v[72:75], a[172:175], a[76:79]
    v_cvt_pk_bf16_f32 v71, v14, v15
    v_mfma_f32_16x16x32_bf16 a[84:87], v[72:75], a[180:183], a[84:87]
    v_cvt_pk_bf16_f32 v68, v8, v9
    v_mfma_f32_16x16x32_bf16 a[116:119], v[76:79], a[180:183], a[96:99]
    v_cvt_pk_bf16_f32 v85, v42, v43
    v_mfma_f32_16x16x32_bf16 a[108:111], v[76:79], a[172:175], a[96:99]
    v_mfma_f32_16x16x32_bf16 a[108:111], v[92:95], a[204:207], a[108:111]
    v_cvt_pk_bf16_f32 v87, v46, v47
    v_mfma_f32_16x16x32_bf16 a[116:119], v[92:95], a[212:215], a[116:119]
    v_cvt_pk_bf16_f32 v80, v32, v33
    v_mfma_f32_16x16x32_bf16 a[100:103], v[92:95], a[196:199], a[100:103]
    v_cvt_pk_bf16_f32 v81, v34, v35
    v_mfma_f32_16x16x32_bf16 a[96:99], v[92:95], a[192:195], a[96:99]
    s_waitcnt lgkmcnt(0)
    v_mfma_f32_16x16x32_bf16 a[96:99], v[76:79], a[160:163], a[96:99]
    s_waitcnt vmcnt(16)
    s_barrier
    v_mfma_f32_16x16x32_bf16 a[64:67], v[72:75], a[160:163], a[64:67]
    v_cvt_pk_bf16_f32 v65, v2, v3
    v_mfma_f32_16x16x32_bf16 a[64:67], v[88:91], a[192:195], a[64:67]
    s_waitcnt lgkmcnt(0)
    s_mov_b32 s26, 0
    s_sub_u32 s25, s25, 8192
.p2align 6
L_loop:
    v_mfma_f32_16x16x32_bf16 v[16:19], a[128:131], v[144:147], v[104:107]
    v_exp_f32 v48, v48
    v_mfma_f32_16x16x32_bf16 v[16:19], a[132:135], v[148:151], v[16:19]
    ds_read_b64_tr_b16 a[192:193], v180 offset:40960
    v_mfma_f32_16x16x32_bf16 v[16:19], a[136:139], v[152:155], v[16:19]
    v_exp_f32 v49, v49
    v_mfma_f32_16x16x32_bf16 v[16:19], a[140:143], v[156:159], v[16:19]
    ds_read_b64_tr_b16 a[194:195], v180 offset:45056
    v_cvt_pk_bf16_f32 v88, v48, v49
    v_mfma_f32_16x16x32_bf16 v[20:23], a[156:159], v[156:159], v[104:107]
    v_exp_f32 v50, v50
    v_mfma_f32_16x16x32_bf16 v[20:23], a[152:155], v[152:155], v[20:23]
    ds_read_b64_tr_b16 a[196:197], v181 offset:40960
    v_mfma_f32_16x16x32_bf16 v[20:23], a[148:151], v[148:151], v[20:23]
    v_exp_f32 v51, v51
    v_mfma_f32_16x16x32_bf16 v[20:23], a[144:147], v[144:147], v[20:23]
    ds_read_b64_tr_b16 a[198:199], v181 offset:45056
    v_cvt_pk_bf16_f32 v89, v50, v51
    v_mfma_f32_16x16x32_bf16 v[28:31], a[144:147], v[160:163], v[108:111]
    v_exp_f32 v52, v52
    v_mfma_f32_16x16x32_bf16 v[28:31], a[148:151], v[164:167], v[28:31]
    ds_read_b64_tr_b16 a[200:201], v182 offset:40960
    v_mfma_f32_16x16x32_bf16 v[28:31], a[152:155], v[168:171], v[28:31]
    v_exp_f32 v53, v53
    v_mfma_f32_16x16x32_bf16 v[28:31], a[156:159], v[172:175], v[28:31]
    ds_read_b64_tr_b16 a[202:203], v182 offset:45056
    v_cvt_pk_bf16_f32 v90, v52, v53
    v_mfma_f32_16x16x32_bf16 v[24:27], a[140:143], v[172:175], v[108:111]
    v_exp_f32 v54, v54
    v_mfma_f32_16x16x32_bf16 v[24:27], a[136:139], v[168:171], v[24:27]
    ds_read_b64_tr_b16 a[204:205], v183 offset:40960
    v_mfma_f32_16x16x32_bf16 v[24:27], a[132:135], v[164:167], v[24:27]
    v_exp_f32 v55, v55
    v_mfma_f32_16x16x32_bf16 v[24:27], a[128:131], v[160:163], v[24:27]
    ds_read_b64_tr_b16 a[206:207], v183 offset:45056
    v_cvt_pk_bf16_f32 v91, v54, v55
    v_mfma_f32_16x16x32_bf16 v[0:3], a[128:131], v[112:115], v[96:99]
    v_exp_f32 v56, v56
    v_mfma_f32_16x16x32_bf16 v[0:3], a[132:135], v[116:119], v[0:3]
    ds_read_b64_tr_b16 a[208:209], v184 offset:40960
    v_mfma_f32_16x16x32_bf16 v[0:3], a[136:139], v[120:123], v[0:3]
    v_exp_f32 v57, v57
    v_mfma_f32_16x16x32_bf16 v[0:3], a[140:143], v[124:127], v[0:3]
    ds_read_b64_tr_b16 a[210:211], v184 offset:45056
    v_cvt_pk_bf16_f32 v92, v56, v57
    v_mfma_f32_16x16x32_bf16 v[4:7], a[156:159], v[124:127], v[96:99]
    v_exp_f32 v58, v58
    v_mfma_f32_16x16x32_bf16 v[4:7], a[152:155], v[120:123], v[4:7]
    ds_read_b64_tr_b16 a[212:213], v185 offset:40960
    v_mfma_f32_16x16x32_bf16 v[4:7], a[148:151], v[116:119], v[4:7]
    v_exp_f32 v59, v59
    v_mfma_f32_16x16x32_bf16 v[4:7], a[144:147], v[112:115], v[4:7]
    ds_read_b64_tr_b16 a[214:215], v185 offset:45056
    v_cvt_pk_bf16_f32 v93, v58, v59
    v_mfma_f32_16x16x32_bf16 v[12:15], a[144:147], v[128:131], v[100:103]
    v_exp_f32 v60, v60
    v_mfma_f32_16x16x32_bf16 v[12:15], a[148:151], v[132:135], v[12:15]
    ds_read_b64_tr_b16 a[216:217], v186 offset:40960
    v_mfma_f32_16x16x32_bf16 v[12:15], a[152:155], v[136:139], v[12:15]
    v_exp_f32 v61, v61
    v_mfma_f32_16x16x32_bf16 v[12:15], a[156:159], v[140:143], v[12:15]
    ds_read_b64_tr_b16 a[218:219], v186 offset:45056
    v_cvt_pk_bf16_f32 v94, v60, v61
    v_mfma_f32_16x16x32_bf16 v[8:11], a[140:143], v[140:143], v[100:103]
    s_waitcnt lgkmcnt(6)
    v_exp_f32 v62, v62
    v_mfma_f32_16x16x32_bf16 v[8:11], a[136:139], v[136:139], v[8:11]
    ds_read_b64_tr_b16 a[220:221], v187 offset:40960
    v_mfma_f32_16x16x32_bf16 v[8:11], a[132:135], v[132:135], v[8:11]
    v_exp_f32 v63, v63
    v_mfma_f32_16x16x32_bf16 v[8:11], a[128:131], v[128:131], v[8:11]
    ds_read_b64_tr_b16 a[222:223], v187 offset:45056
    v_cvt_pk_bf16_f32 v95, v62, v63
    v_mfma_f32_16x16x32_bf16 a[0:3], v[64:67], a[160:163], a[0:3]
    v_exp_f32 v16, v16
    v_mfma_f32_16x16x32_bf16 a[0:3], v[80:83], a[192:195], a[0:3]
    ds_read_b128 a[128:131], v176 offset:57344
    v_mfma_f32_16x16x32_bf16 a[32:35], v[84:87], a[192:195], a[32:35]
    v_exp_f32 v17, v17
    v_mfma_f32_16x16x32_bf16 a[32:35], v[68:71], a[160:163], a[32:35]
    ds_read_b128 a[132:135], v177 offset:57344
    v_cvt_pk_bf16_f32 v72, v16, v17
    v_mfma_f32_16x16x32_bf16 a[36:39], v[68:71], a[164:167], a[36:39]
    v_exp_f32 v18, v18
    v_mfma_f32_16x16x32_bf16 a[36:39], v[84:87], a[196:199], a[36:39]
    ds_read_b128 a[136:139], v178 offset:57344
    v_mfma_f32_16x16x32_bf16 a[4:7], v[80:83], a[196:199], a[4:7]
    v_exp_f32 v19, v19
    v_mfma_f32_16x16x32_bf16 a[4:7], v[64:67], a[164:167], a[4:7]
    ds_read_b128 a[140:143], v179 offset:57344
    v_cvt_pk_bf16_f32 v73, v18, v19
    v_mfma_f32_16x16x32_bf16 a[8:11], v[64:67], a[168:171], a[8:11]
    s_add_u32 s25, s25, 8192
    v_exp_f32 v20, v20
    v_mfma_f32_16x16x32_bf16 a[8:11], v[80:83], a[200:203], a[8:11]
    ds_read_b128 a[144:147], v176 offset:61440
    v_mfma_f32_16x16x32_bf16 a[40:43], v[84:87], a[200:203], a[40:43]
    v_exp_f32 v21, v21
    v_mfma_f32_16x16x32_bf16 a[40:43], v[68:71], a[168:171], a[40:43]
    ds_read_b128 a[148:151], v177 offset:61440
    v_cvt_pk_bf16_f32 v74, v20, v21
    v_mfma_f32_16x16x32_bf16 a[44:47], v[68:71], a[172:175], a[44:47]
    s_waitcnt lgkmcnt(6)
    v_exp_f32 v22, v22
    v_mfma_f32_16x16x32_bf16 a[44:47], v[84:87], a[204:207], a[44:47]
    ds_read_b128 a[152:155], v178 offset:61440
    v_mfma_f32_16x16x32_bf16 a[12:15], v[80:83], a[204:207], a[12:15]
    v_exp_f32 v23, v23
    v_mfma_f32_16x16x32_bf16 a[12:15], v[64:67], a[172:175], a[12:15]
    ds_read_b128 a[156:159], v179 offset:61440
    v_cvt_pk_bf16_f32 v75, v22, v23
    v_mfma_f32_16x16x32_bf16 a[16:19], v[64:67], a[176:179], a[16:19]
    s_and_b32 s25, s25, 0x7ffff
    v_exp_f32 v24, v24
    v_mfma_f32_16x16x32_bf16 a[16:19], v[80:83], a[208:211], a[16:19]
    s_add_u32 m0, s21, 40960
    v_exp_f32 v25, v25
    v_mfma_f32_16x16x32_bf16 a[48:51], v[84:87], a[208:211], a[48:51]
    v_cvt_pk_bf16_f32 v76, v24, v25
    v_mfma_f32_16x16x32_bf16 a[48:51], v[68:71], a[176:179], a[48:51]
    buffer_load_dwordx4 v188, s[4:7], s24 offen lds
    v_mfma_f32_16x16x32_bf16 a[52:55], v[68:71], a[180:183], a[52:55]
    v_exp_f32 v26, v26
    v_mfma_f32_16x16x32_bf16 a[52:55], v[84:87], a[212:215], a[52:55]
    v_exp_f32 v27, v27
    v_mfma_f32_16x16x32_bf16 a[20:23], v[80:83], a[212:215], a[20:23]
    v_cvt_pk_bf16_f32 v77, v26, v27
    v_mfma_f32_16x16x32_bf16 a[20:23], v[64:67], a[180:183], a[20:23]
    buffer_load_dwordx4 v189, s[4:7], s24 offen offset:1024 lds
    v_mfma_f32_16x16x32_bf16 a[24:27], v[64:67], a[184:187], a[24:27]
    s_add_u32 s24, s24, 8192
    v_exp_f32 v28, v28
    v_mfma_f32_16x16x32_bf16 a[24:27], v[80:83], a[216:219], a[24:27]
    s_add_u32 m0, s22, 24576
    v_exp_f32 v29, v29
    v_mfma_f32_16x16x32_bf16 a[56:59], v[84:87], a[216:219], a[56:59]
    s_and_b32 s24, s24, 0x7ffff
    v_cvt_pk_bf16_f32 v78, v28, v29
    v_mfma_f32_16x16x32_bf16 a[56:59], v[68:71], a[184:187], a[56:59]
    buffer_load_dwordx4 v190, s[8:11], s25 offen lds
    v_mfma_f32_16x16x32_bf16 a[60:63], v[68:71], a[188:191], a[60:63]
    v_exp_f32 v30, v30
    v_mfma_f32_16x16x32_bf16 a[60:63], v[84:87], a[220:223], a[60:63]
    v_exp_f32 v31, v31
    v_mfma_f32_16x16x32_bf16 a[28:31], v[80:83], a[220:223], a[28:31]
    s_waitcnt lgkmcnt(0)
    v_cvt_pk_bf16_f32 v79, v30, v31
    v_mfma_f32_16x16x32_bf16 a[28:31], v[64:67], a[188:191], a[28:31]
    buffer_load_dwordx4 v191, s[8:11], s25 offen offset:1024 lds
    v_smfmac_f32_16x16x64_bf16 a[224:227], v[192:195], v[64:71], v196
    v_smfmac_f32_16x16x64_bf16 a[224:227], v[192:195], v[80:87], v196
    v_mfma_f32_16x16x32_bf16 v[32:35], a[128:131], v[112:115], v[96:99]
    v_exp_f32 v0, v0
    v_mfma_f32_16x16x32_bf16 v[32:35], a[132:135], v[116:119], v[32:35]
    ds_read_b64_tr_b16 a[160:161], v180 offset:49152
    v_mfma_f32_16x16x32_bf16 v[32:35], a[136:139], v[120:123], v[32:35]
    v_exp_f32 v1, v1
    v_mfma_f32_16x16x32_bf16 v[32:35], a[140:143], v[124:127], v[32:35]
    ds_read_b64_tr_b16 a[162:163], v180 offset:53248
    v_cvt_pk_bf16_f32 v64, v0, v1
    v_mfma_f32_16x16x32_bf16 v[36:39], a[156:159], v[124:127], v[96:99]
    v_exp_f32 v2, v2
    v_mfma_f32_16x16x32_bf16 v[36:39], a[152:155], v[120:123], v[36:39]
    ds_read_b64_tr_b16 a[164:165], v181 offset:49152
    v_mfma_f32_16x16x32_bf16 v[36:39], a[148:151], v[116:119], v[36:39]
    v_exp_f32 v3, v3
    v_mfma_f32_16x16x32_bf16 v[36:39], a[144:147], v[112:115], v[36:39]
    ds_read_b64_tr_b16 a[166:167], v181 offset:53248
    v_cvt_pk_bf16_f32 v65, v2, v3
    v_mfma_f32_16x16x32_bf16 v[44:47], a[144:147], v[128:131], v[100:103]
    v_exp_f32 v4, v4
    v_mfma_f32_16x16x32_bf16 v[44:47], a[148:151], v[132:135], v[44:47]
    ds_read_b64_tr_b16 a[168:169], v182 offset:49152
    v_mfma_f32_16x16x32_bf16 v[44:47], a[152:155], v[136:139], v[44:47]
    v_exp_f32 v5, v5
    v_mfma_f32_16x16x32_bf16 v[44:47], a[156:159], v[140:143], v[44:47]
    ds_read_b64_tr_b16 a[170:171], v182 offset:53248
    v_cvt_pk_bf16_f32 v66, v4, v5
    v_mfma_f32_16x16x32_bf16 v[40:43], a[140:143], v[140:143], v[100:103]
    v_exp_f32 v6, v6
    v_mfma_f32_16x16x32_bf16 v[40:43], a[136:139], v[136:139], v[40:43]
    ds_read_b64_tr_b16 a[172:173], v183 offset:49152
    v_mfma_f32_16x16x32_bf16 v[40:43], a[132:135], v[132:135], v[40:43]
    v_exp_f32 v7, v7
    v_mfma_f32_16x16x32_bf16 v[40:43], a[128:131], v[128:131], v[40:43]
    ds_read_b64_tr_b16 a[174:175], v183 offset:53248
    v_cvt_pk_bf16_f32 v67, v6, v7
    v_mfma_f32_16x16x32_bf16 v[48:51], a[128:131], v[144:147], v[104:107]
    v_exp_f32 v8, v8
    v_mfma_f32_16x16x32_bf16 v[48:51], a[132:135], v[148:151], v[48:51]
    ds_read_b64_tr_b16 a[176:177], v184 offset:49152
    v_mfma_f32_16x16x32_bf16 v[48:51], a[136:139], v[152:155], v[48:51]
    v_exp_f32 v9, v9
    v_mfma_f32_16x16x32_bf16 v[48:51], a[140:143], v[156:159], v[48:51]
    ds_read_b64_tr_b16 a[178:179], v184 offset:53248
    v_cvt_pk_bf16_f32 v68, v8, v9
    v_mfma_f32_16x16x32_bf16 v[52:55], a[156:159], v[156:159], v[104:107]
    v_exp_f32 v10, v10
    v_mfma_f32_16x16x32_bf16 v[52:55], a[152:155], v[152:155], v[52:55]
    ds_read_b64_tr_b16 a[180:181], v185 offset:49152
    v_mfma_f32_16x16x32_bf16 v[52:55], a[148:151], v[148:151], v[52:55]
    v_exp_f32 v11, v11
    v_mfma_f32_16x16x32_bf16 v[52:55], a[144:147], v[144:147], v[52:55]
    ds_read_b64_tr_b16 a[182:183], v185 offset:53248
    v_cvt_pk_bf16_f32 v69, v10, v11
    v_mfma_f32_16x16x32_bf16 v[60:63], a[144:147], v[160:163], v[108:111]
    v_exp_f32 v12, v12
    v_mfma_f32_16x16x32_bf16 v[60:63], a[148:151], v[164:167], v[60:63]
    ds_read_b64_tr_b16 a[184:185], v186 offset:49152
    v_mfma_f32_16x16x32_bf16 v[60:63], a[152:155], v[168:171], v[60:63]
    v_exp_f32 v13, v13
    v_mfma_f32_16x16x32_bf16 v[60:63], a[156:159], v[172:175], v[60:63]
    ds_read_b64_tr_b16 a[186:187], v186 offset:53248
    v_cvt_pk_bf16_f32 v70, v12, v13
    v_mfma_f32_16x16x32_bf16 v[56:59], a[140:143], v[172:175], v[108:111]
    s_waitcnt lgkmcnt(6)
    v_exp_f32 v14, v14
    v_mfma_f32_16x16x32_bf16 v[56:59], a[136:139], v[168:171], v[56:59]
    ds_read_b64_tr_b16 a[188:189], v187 offset:49152
    v_mfma_f32_16x16x32_bf16 v[56:59], a[132:135], v[164:167], v[56:59]
    v_exp_f32 v15, v15
    v_mfma_f32_16x16x32_bf16 v[56:59], a[128:131], v[160:163], v[56:59]
    ds_read_b64_tr_b16 a[190:191], v187 offset:53248
    v_cvt_pk_bf16_f32 v71, v14, v15
    v_mfma_f32_16x16x32_bf16 a[64:67], v[88:91], a[192:195], a[64:67]
    v_exp_f32 v32, v32
    v_mfma_f32_16x16x32_bf16 a[64:67], v[72:75], a[160:163], a[64:67]
    ds_read_b128 a[128:131], v176 offset:0
    v_mfma_f32_16x16x32_bf16 a[96:99], v[76:79], a[160:163], a[96:99]
    v_exp_f32 v33, v33
    v_mfma_f32_16x16x32_bf16 a[96:99], v[92:95], a[192:195], a[96:99]
    ds_read_b128 a[132:135], v177 offset:0
    v_cvt_pk_bf16_f32 v80, v32, v33
    v_mfma_f32_16x16x32_bf16 a[100:103], v[92:95], a[196:199], a[100:103]
    v_exp_f32 v34, v34
    v_mfma_f32_16x16x32_bf16 a[100:103], v[76:79], a[164:167], a[100:103]
    ds_read_b128 a[136:139], v178 offset:0
    v_mfma_f32_16x16x32_bf16 a[68:71], v[72:75], a[164:167], a[68:71]
    v_exp_f32 v35, v35
    v_mfma_f32_16x16x32_bf16 a[68:71], v[88:91], a[196:199], a[68:71]
    ds_read_b128 a[140:143], v179 offset:0
    v_cvt_pk_bf16_f32 v81, v34, v35
    v_mfma_f32_16x16x32_bf16 a[72:75], v[88:91], a[200:203], a[72:75]
    s_add_u32 s25, s25, 8192
    v_exp_f32 v36, v36
    v_mfma_f32_16x16x32_bf16 a[72:75], v[72:75], a[168:171], a[72:75]
    ds_read_b128 a[144:147], v176 offset:4096
    v_mfma_f32_16x16x32_bf16 a[104:107], v[76:79], a[168:171], a[104:107]
    v_exp_f32 v37, v37
    v_mfma_f32_16x16x32_bf16 a[104:107], v[92:95], a[200:203], a[104:107]
    ds_read_b128 a[148:151], v177 offset:4096
    v_cvt_pk_bf16_f32 v82, v36, v37
    v_mfma_f32_16x16x32_bf16 a[108:111], v[92:95], a[204:207], a[108:111]
    s_waitcnt lgkmcnt(6)
    v_exp_f32 v38, v38
    v_mfma_f32_16x16x32_bf16 a[108:111], v[76:79], a[172:175], a[108:111]
    ds_read_b128 a[152:155], v178 offset:4096
    v_mfma_f32_16x16x32_bf16 a[76:79], v[72:75], a[172:175], a[76:79]
    v_exp_f32 v39, v39
    v_mfma_f32_16x16x32_bf16 a[76:79], v[88:91], a[204:207], a[76:79]
    ds_read_b128 a[156:159], v179 offset:4096
    v_cvt_pk_bf16_f32 v83, v38, v39
    v_mfma_f32_16x16x32_bf16 a[80:83], v[88:91], a[208:211], a[80:83]
    s_and_b32 s25, s25, 0x7ffff
    v_exp_f32 v40, v40
    v_mfma_f32_16x16x32_bf16 a[80:83], v[72:75], a[176:179], a[80:83]
    s_add_u32 m0, s21, 49152
    v_exp_f32 v41, v41
    v_mfma_f32_16x16x32_bf16 a[112:115], v[76:79], a[176:179], a[112:115]
    v_cvt_pk_bf16_f32 v84, v40, v41
    v_mfma_f32_16x16x32_bf16 a[112:115], v[92:95], a[208:211], a[112:115]
    buffer_load_dwordx4 v188, s[4:7], s24 offen lds
    v_mfma_f32_16x16x32_bf16 a[116:119], v[92:95], a[212:215], a[116:119]
    v_exp_f32 v42, v42
    v_mfma_f32_16x16x32_bf16 a[116:119], v[76:79], a[180:183], a[116:119]
    v_exp_f32 v43, v43
    v_mfma_f32_16x16x32_bf16 a[84:87], v[72:75], a[180:183], a[84:87]
    v_cvt_pk_bf16_f32 v85, v42, v43
    v_mfma_f32_16x16x32_bf16 a[84:87], v[88:91], a[212:215], a[84:87]
    buffer_load_dwordx4 v189, s[4:7], s24 offen offset:1024 lds
    v_mfma_f32_16x16x32_bf16 a[88:91], v[88:91], a[216:219], a[88:91]
    s_add_u32 s24, s24, 8192
    v_exp_f32 v44, v44
    v_mfma_f32_16x16x32_bf16 a[88:91], v[72:75], a[184:187], a[88:91]
    s_add_u32 m0, s22, 32768
    v_exp_f32 v45, v45
    v_mfma_f32_16x16x32_bf16 a[120:123], v[76:79], a[184:187], a[120:123]
    s_and_b32 s24, s24, 0x7ffff
    v_cvt_pk_bf16_f32 v86, v44, v45
    v_mfma_f32_16x16x32_bf16 a[120:123], v[92:95], a[216:219], a[120:123]
    buffer_load_dwordx4 v190, s[8:11], s25 offen lds
    v_mfma_f32_16x16x32_bf16 a[124:127], v[92:95], a[220:223], a[124:127]
    s_waitcnt vmcnt(7)
    v_exp_f32 v46, v46
    v_mfma_f32_16x16x32_bf16 a[124:127], v[76:79], a[188:191], a[124:127]
    v_exp_f32 v47, v47
    v_mfma_f32_16x16x32_bf16 a[92:95], v[72:75], a[188:191], a[92:95]
    s_waitcnt lgkmcnt(0)
    v_cvt_pk_bf16_f32 v87, v46, v47
    v_mfma_f32_16x16x32_bf16 a[92:95], v[88:91], a[220:223], a[92:95]
    buffer_load_dwordx4 v191, s[8:11], s25 offen offset:1024 lds
    v_smfmac_f32_16x16x64_bf16 a[228:231], v[192:195], v[88:95], v196
    s_barrier
    v_smfmac_f32_16x16x64_bf16 a[228:231], v[192:195], v[72:79], v196
    s_cmp_eq_u32 s26, 7
    s_cbranch_scc1 L_tail
    v_mfma_f32_16x16x32_bf16 v[16:19], a[128:131], v[144:147], v[104:107]
    v_exp_f32 v48, v48
    v_mfma_f32_16x16x32_bf16 v[16:19], a[132:135], v[148:151], v[16:19]
    ds_read_b64_tr_b16 a[192:193], v180 offset:57344
    v_mfma_f32_16x16x32_bf16 v[16:19], a[136:139], v[152:155], v[16:19]
    v_exp_f32 v49, v49
    v_mfma_f32_16x16x32_bf16 v[16:19], a[140:143], v[156:159], v[16:19]
    ds_read_b64_tr_b16 a[194:195], v180 offset:61440
    v_cvt_pk_bf16_f32 v88, v48, v49
    v_mfma_f32_16x16x32_bf16 v[20:23], a[156:159], v[156:159], v[104:107]
    v_exp_f32 v50, v50
    v_mfma_f32_16x16x32_bf16 v[20:23], a[152:155], v[152:155], v[20:23]
    ds_read_b64_tr_b16 a[196:197], v181 offset:57344
    v_mfma_f32_16x16x32_bf16 v[20:23], a[148:151], v[148:151], v[20:23]
    v_exp_f32 v51, v51
    v_mfma_f32_16x16x32_bf16 v[20:23], a[144:147], v[144:147], v[20:23]
    ds_read_b64_tr_b16 a[198:199], v181 offset:61440
    v_cvt_pk_bf16_f32 v89, v50, v51
    v_mfma_f32_16x16x32_bf16 v[28:31], a[144:147], v[160:163], v[108:111]
    v_exp_f32 v52, v52
    v_mfma_f32_16x16x32_bf16 v[28:31], a[148:151], v[164:167], v[28:31]
    ds_read_b64_tr_b16 a[200:201], v182 offset:57344
    v_mfma_f32_16x16x32_bf16 v[28:31], a[152:155], v[168:171], v[28:31]
    v_exp_f32 v53, v53
    v_mfma_f32_16x16x32_bf16 v[28:31], a[156:159], v[172:175], v[28:31]
    ds_read_b64_tr_b16 a[202:203], v182 offset:61440
    v_cvt_pk_bf16_f32 v90, v52, v53
    v_mfma_f32_16x16x32_bf16 v[24:27], a[140:143], v[172:175], v[108:111]
    v_exp_f32 v54, v54
    v_mfma_f32_16x16x32_bf16 v[24:27], a[136:139], v[168:171], v[24:27]
    ds_read_b64_tr_b16 a[204:205], v183 offset:57344
    v_mfma_f32_16x16x32_bf16 v[24:27], a[132:135], v[164:167], v[24:27]
    v_exp_f32 v55, v55
    v_mfma_f32_16x16x32_bf16 v[24:27], a[128:131], v[160:163], v[24:27]
    ds_read_b64_tr_b16 a[206:207], v183 offset:61440
    v_cvt_pk_bf16_f32 v91, v54, v55
    v_mfma_f32_16x16x32_bf16 v[0:3], a[128:131], v[112:115], v[96:99]
    v_exp_f32 v56, v56
    v_mfma_f32_16x16x32_bf16 v[0:3], a[132:135], v[116:119], v[0:3]
    ds_read_b64_tr_b16 a[208:209], v184 offset:57344
    v_mfma_f32_16x16x32_bf16 v[0:3], a[136:139], v[120:123], v[0:3]
    v_exp_f32 v57, v57
    v_mfma_f32_16x16x32_bf16 v[0:3], a[140:143], v[124:127], v[0:3]
    ds_read_b64_tr_b16 a[210:211], v184 offset:61440
    v_cvt_pk_bf16_f32 v92, v56, v57
    v_mfma_f32_16x16x32_bf16 v[4:7], a[156:159], v[124:127], v[96:99]
    v_exp_f32 v58, v58
    v_mfma_f32_16x16x32_bf16 v[4:7], a[152:155], v[120:123], v[4:7]
    ds_read_b64_tr_b16 a[212:213], v185 offset:57344
    v_mfma_f32_16x16x32_bf16 v[4:7], a[148:151], v[116:119], v[4:7]
    v_exp_f32 v59, v59
    v_mfma_f32_16x16x32_bf16 v[4:7], a[144:147], v[112:115], v[4:7]
    ds_read_b64_tr_b16 a[214:215], v185 offset:61440
    v_cvt_pk_bf16_f32 v93, v58, v59
    v_mfma_f32_16x16x32_bf16 v[12:15], a[144:147], v[128:131], v[100:103]
    v_exp_f32 v60, v60
    v_mfma_f32_16x16x32_bf16 v[12:15], a[148:151], v[132:135], v[12:15]
    ds_read_b64_tr_b16 a[216:217], v186 offset:57344
    v_mfma_f32_16x16x32_bf16 v[12:15], a[152:155], v[136:139], v[12:15]
    v_exp_f32 v61, v61
    v_mfma_f32_16x16x32_bf16 v[12:15], a[156:159], v[140:143], v[12:15]
    ds_read_b64_tr_b16 a[218:219], v186 offset:61440
    v_cvt_pk_bf16_f32 v94, v60, v61
    v_mfma_f32_16x16x32_bf16 v[8:11], a[140:143], v[140:143], v[100:103]
    s_waitcnt lgkmcnt(6)
    v_exp_f32 v62, v62
    v_mfma_f32_16x16x32_bf16 v[8:11], a[136:139], v[136:139], v[8:11]
    ds_read_b64_tr_b16 a[220:221], v187 offset:57344
    v_mfma_f32_16x16x32_bf16 v[8:11], a[132:135], v[132:135], v[8:11]
    v_exp_f32 v63, v63
    v_mfma_f32_16x16x32_bf16 v[8:11], a[128:131], v[128:131], v[8:11]
    ds_read_b64_tr_b16 a[222:223], v187 offset:61440
    v_cvt_pk_bf16_f32 v95, v62, v63
    v_mfma_f32_16x16x32_bf16 a[0:3], v[64:67], a[160:163], a[0:3]
    v_exp_f32 v16, v16
    v_mfma_f32_16x16x32_bf16 a[0:3], v[80:83], a[192:195], a[0:3]
    ds_read_b128 a[128:131], v176 offset:8192
    v_mfma_f32_16x16x32_bf16 a[32:35], v[84:87], a[192:195], a[32:35]
    v_exp_f32 v17, v17
    v_mfma_f32_16x16x32_bf16 a[32:35], v[68:71], a[160:163], a[32:35]
    ds_read_b128 a[132:135], v177 offset:8192
    v_cvt_pk_bf16_f32 v72, v16, v17
    v_mfma_f32_16x16x32_bf16 a[36:39], v[68:71], a[164:167], a[36:39]
    v_exp_f32 v18, v18
    v_mfma_f32_16x16x32_bf16 a[36:39], v[84:87], a[196:199], a[36:39]
    ds_read_b128 a[136:139], v178 offset:8192
    v_mfma_f32_16x16x32_bf16 a[4:7], v[80:83], a[196:199], a[4:7]
    v_exp_f32 v19, v19
    v_mfma_f32_16x16x32_bf16 a[4:7], v[64:67], a[164:167], a[4:7]
    ds_read_b128 a[140:143], v179 offset:8192
    v_cvt_pk_bf16_f32 v73, v18, v19
    v_mfma_f32_16x16x32_bf16 a[8:11], v[64:67], a[168:171], a[8:11]
    s_add_u32 s25, s25, 8192
    v_exp_f32 v20, v20
    v_mfma_f32_16x16x32_bf16 a[8:11], v[80:83], a[200:203], a[8:11]
    ds_read_b128 a[144:147], v176 offset:12288
    v_mfma_f32_16x16x32_bf16 a[40:43], v[84:87], a[200:203], a[40:43]
    v_exp_f32 v21, v21
    v_mfma_f32_16x16x32_bf16 a[40:43], v[68:71], a[168:171], a[40:43]
    ds_read_b128 a[148:151], v177 offset:12288
    v_cvt_pk_bf16_f32 v74, v20, v21
    v_mfma_f32_16x16x32_bf16 a[44:47], v[68:71], a[172:175], a[44:47]
    s_waitcnt lgkmcnt(6)
    v_exp_f32 v22, v22
    v_mfma_f32_16x16x32_bf16 a[44:47], v[84:87], a[204:207], a[44:47]
    ds_read_b128 a[152:155], v178 offset:12288
    v_mfma_f32_16x16x32_bf16 a[12:15], v[80:83], a[204:207], a[12:15]
    v_exp_f32 v23, v23
    v_mfma_f32_16x16x32_bf16 a[12:15], v[64:67], a[172:175], a[12:15]
    ds_read_b128 a[156:159], v179 offset:12288
    v_cvt_pk_bf16_f32 v75, v22, v23
    v_mfma_f32_16x16x32_bf16 a[16:19], v[64:67], a[176:179], a[16:19]
    s_and_b32 s25, s25, 0x7ffff
    v_exp_f32 v24, v24
    v_mfma_f32_16x16x32_bf16 a[16:19], v[80:83], a[208:211], a[16:19]
    s_add_u32 m0, s21, 57344
    v_exp_f32 v25, v25
    v_mfma_f32_16x16x32_bf16 a[48:51], v[84:87], a[208:211], a[48:51]
    v_cvt_pk_bf16_f32 v76, v24, v25
    v_mfma_f32_16x16x32_bf16 a[48:51], v[68:71], a[176:179], a[48:51]
    buffer_load_dwordx4 v188, s[4:7], s24 offen lds
    v_mfma_f32_16x16x32_bf16 a[52:55], v[68:71], a[180:183], a[52:55]
    v_exp_f32 v26, v26
    v_mfma_f32_16x16x32_bf16 a[52:55], v[84:87], a[212:215], a[52:55]
    v_exp_f32 v27, v27
    v_mfma_f32_16x16x32_bf16 a[20:23], v[80:83], a[212:215], a[20:23]
    v_cvt_pk_bf16_f32 v77, v26, v27
    v_mfma_f32_16x16x32_bf16 a[20:23], v[64:67], a[180:183], a[20:23]
    buffer_load_dwordx4 v189, s[4:7], s24 offen offset:1024 lds
    v_mfma_f32_16x16x32_bf16 a[24:27], v[64:67], a[184:187], a[24:27]
    s_add_u32 s24, s24, 8192
    v_exp_f32 v28, v28
    v_mfma_f32_16x16x32_bf16 a[24:27], v[80:83], a[216:219], a[24:27]
    s_add_u32 m0, s22, 40960
    v_exp_f32 v29, v29
    v_mfma_f32_16x16x32_bf16 a[56:59], v[84:87], a[216:219], a[56:59]
    s_and_b32 s24, s24, 0x7ffff
    v_cvt_pk_bf16_f32 v78, v28, v29
    v_mfma_f32_16x16x32_bf16 a[56:59], v[68:71], a[184:187], a[56:59]
    buffer_load_dwordx4 v190, s[8:11], s25 offen lds
    v_mfma_f32_16x16x32_bf16 a[60:63], v[68:71], a[188:191], a[60:63]
    v_exp_f32 v30, v30
    v_mfma_f32_16x16x32_bf16 a[60:63], v[84:87], a[220:223], a[60:63]
    v_exp_f32 v31, v31
    v_mfma_f32_16x16x32_bf16 a[28:31], v[80:83], a[220:223], a[28:31]
    s_waitcnt lgkmcnt(0)
    v_cvt_pk_bf16_f32 v79, v30, v31
    v_mfma_f32_16x16x32_bf16 a[28:31], v[64:67], a[188:191], a[28:31]
    buffer_load_dwordx4 v191, s[8:11], s25 offen offset:1024 lds
    v_smfmac_f32_16x16x64_bf16 a[224:227], v[192:195], v[64:71], v196
    v_smfmac_f32_16x16x64_bf16 a[224:227], v[192:195], v[80:87], v196
    v_mfma_f32_16x16x32_bf16 v[32:35], a[128:131], v[112:115], v[96:99]
    v_exp_f32 v0, v0
    v_mfma_f32_16x16x32_bf16 v[32:35], a[132:135], v[116:119], v[32:35]
    ds_read_b64_tr_b16 a[160:161], v180 offset:0
    v_mfma_f32_16x16x32_bf16 v[32:35], a[136:139], v[120:123], v[32:35]
    v_exp_f32 v1, v1
    v_mfma_f32_16x16x32_bf16 v[32:35], a[140:143], v[124:127], v[32:35]
    ds_read_b64_tr_b16 a[162:163], v180 offset:4096
    v_cvt_pk_bf16_f32 v64, v0, v1
    v_mfma_f32_16x16x32_bf16 v[36:39], a[156:159], v[124:127], v[96:99]
    v_exp_f32 v2, v2
    v_mfma_f32_16x16x32_bf16 v[36:39], a[152:155], v[120:123], v[36:39]
    ds_read_b64_tr_b16 a[164:165], v181 offset:0
    v_mfma_f32_16x16x32_bf16 v[36:39], a[148:151], v[116:119], v[36:39]
    v_exp_f32 v3, v3
    v_mfma_f32_16x16x32_bf16 v[36:39], a[144:147], v[112:115], v[36:39]
    ds_read_b64_tr_b16 a[166:167], v181 offset:4096
    v_cvt_pk_bf16_f32 v65, v2, v3
    v_mfma_f32_16x16x32_bf16 v[44:47], a[144:147], v[128:131], v[100:103]
    v_exp_f32 v4, v4
    v_mfma_f32_16x16x32_bf16 v[44:47], a[148:151], v[132:135], v[44:47]
    ds_read_b64_tr_b16 a[168:169], v182 offset:0
    v_mfma_f32_16x16x32_bf16 v[44:47], a[152:155], v[136:139], v[44:47]
    v_exp_f32 v5, v5
    v_mfma_f32_16x16x32_bf16 v[44:47], a[156:159], v[140:143], v[44:47]
    ds_read_b64_tr_b16 a[170:171], v182 offset:4096
    v_cvt_pk_bf16_f32 v66, v4, v5
    v_mfma_f32_16x16x32_bf16 v[40:43], a[140:143], v[140:143], v[100:103]
    v_exp_f32 v6, v6
    v_mfma_f32_16x16x32_bf16 v[40:43], a[136:139], v[136:139], v[40:43]
    ds_read_b64_tr_b16 a[172:173], v183 offset:0
    v_mfma_f32_16x16x32_bf16 v[40:43], a[132:135], v[132:135], v[40:43]
    v_exp_f32 v7, v7
    v_mfma_f32_16x16x32_bf16 v[40:43], a[128:131], v[128:131], v[40:43]
    ds_read_b64_tr_b16 a[174:175], v183 offset:4096
    v_cvt_pk_bf16_f32 v67, v6, v7
    v_mfma_f32_16x16x32_bf16 v[48:51], a[128:131], v[144:147], v[104:107]
    v_exp_f32 v8, v8
    v_mfma_f32_16x16x32_bf16 v[48:51], a[132:135], v[148:151], v[48:51]
    ds_read_b64_tr_b16 a[176:177], v184 offset:0
    v_mfma_f32_16x16x32_bf16 v[48:51], a[136:139], v[152:155], v[48:51]
    v_exp_f32 v9, v9
    v_mfma_f32_16x16x32_bf16 v[48:51], a[140:143], v[156:159], v[48:51]
    ds_read_b64_tr_b16 a[178:179], v184 offset:4096
    v_cvt_pk_bf16_f32 v68, v8, v9
    v_mfma_f32_16x16x32_bf16 v[52:55], a[156:159], v[156:159], v[104:107]
    v_exp_f32 v10, v10
    v_mfma_f32_16x16x32_bf16 v[52:55], a[152:155], v[152:155], v[52:55]
    ds_read_b64_tr_b16 a[180:181], v185 offset:0
    v_mfma_f32_16x16x32_bf16 v[52:55], a[148:151], v[148:151], v[52:55]
    v_exp_f32 v11, v11
    v_mfma_f32_16x16x32_bf16 v[52:55], a[144:147], v[144:147], v[52:55]
    ds_read_b64_tr_b16 a[182:183], v185 offset:4096
    v_cvt_pk_bf16_f32 v69, v10, v11
    v_mfma_f32_16x16x32_bf16 v[60:63], a[144:147], v[160:163], v[108:111]
    v_exp_f32 v12, v12
    v_mfma_f32_16x16x32_bf16 v[60:63], a[148:151], v[164:167], v[60:63]
    ds_read_b64_tr_b16 a[184:185], v186 offset:0
    v_mfma_f32_16x16x32_bf16 v[60:63], a[152:155], v[168:171], v[60:63]
    v_exp_f32 v13, v13
    v_mfma_f32_16x16x32_bf16 v[60:63], a[156:159], v[172:175], v[60:63]
    ds_read_b64_tr_b16 a[186:187], v186 offset:4096
    v_cvt_pk_bf16_f32 v70, v12, v13
    v_mfma_f32_16x16x32_bf16 v[56:59], a[140:143], v[172:175], v[108:111]
    s_waitcnt lgkmcnt(6)
    v_exp_f32 v14, v14
    v_mfma_f32_16x16x32_bf16 v[56:59], a[136:139], v[168:171], v[56:59]
    ds_read_b64_tr_b16 a[188:189], v187 offset:0
    v_mfma_f32_16x16x32_bf16 v[56:59], a[132:135], v[164:167], v[56:59]
    v_exp_f32 v15, v15
    v_mfma_f32_16x16x32_bf16 v[56:59], a[128:131], v[160:163], v[56:59]
    ds_read_b64_tr_b16 a[190:191], v187 offset:4096
    v_cvt_pk_bf16_f32 v71, v14, v15
    v_mfma_f32_16x16x32_bf16 a[64:67], v[88:91], a[192:195], a[64:67]
    v_exp_f32 v32, v32
    v_mfma_f32_16x16x32_bf16 a[64:67], v[72:75], a[160:163], a[64:67]
    ds_read_b128 a[128:131], v176 offset:16384
    v_mfma_f32_16x16x32_bf16 a[96:99], v[76:79], a[160:163], a[96:99]
    v_exp_f32 v33, v33
    v_mfma_f32_16x16x32_bf16 a[96:99], v[92:95], a[192:195], a[96:99]
    ds_read_b128 a[132:135], v177 offset:16384
    v_cvt_pk_bf16_f32 v80, v32, v33
    v_mfma_f32_16x16x32_bf16 a[100:103], v[92:95], a[196:199], a[100:103]
    v_exp_f32 v34, v34
    v_mfma_f32_16x16x32_bf16 a[100:103], v[76:79], a[164:167], a[100:103]
    ds_read_b128 a[136:139], v178 offset:16384
    v_mfma_f32_16x16x32_bf16 a[68:71], v[72:75], a[164:167], a[68:71]
    v_exp_f32 v35, v35
    v_mfma_f32_16x16x32_bf16 a[68:71], v[88:91], a[196:199], a[68:71]
    ds_read_b128 a[140:143], v179 offset:16384
    v_cvt_pk_bf16_f32 v81, v34, v35
    v_mfma_f32_16x16x32_bf16 a[72:75], v[88:91], a[200:203], a[72:75]
    s_add_u32 s25, s25, 8192
    v_exp_f32 v36, v36
    v_mfma_f32_16x16x32_bf16 a[72:75], v[72:75], a[168:171], a[72:75]
    ds_read_b128 a[144:147], v176 offset:20480
    v_mfma_f32_16x16x32_bf16 a[104:107], v[76:79], a[168:171], a[104:107]
    v_exp_f32 v37, v37
    v_mfma_f32_16x16x32_bf16 a[104:107], v[92:95], a[200:203], a[104:107]
    ds_read_b128 a[148:151], v177 offset:20480
    v_cvt_pk_bf16_f32 v82, v36, v37
    v_mfma_f32_16x16x32_bf16 a[108:111], v[92:95], a[204:207], a[108:111]
    s_waitcnt lgkmcnt(6)
    v_exp_f32 v38, v38
    v_mfma_f32_16x16x32_bf16 a[108:111], v[76:79], a[172:175], a[108:111]
    ds_read_b128 a[152:155], v178 offset:20480
    v_mfma_f32_16x16x32_bf16 a[76:79], v[72:75], a[172:175], a[76:79]
    v_exp_f32 v39, v39
    v_mfma_f32_16x16x32_bf16 a[76:79], v[88:91], a[204:207], a[76:79]
    ds_read_b128 a[156:159], v179 offset:20480
    v_cvt_pk_bf16_f32 v83, v38, v39
    v_mfma_f32_16x16x32_bf16 a[80:83], v[88:91], a[208:211], a[80:83]
    s_and_b32 s25, s25, 0x7ffff
    v_exp_f32 v40, v40
    v_mfma_f32_16x16x32_bf16 a[80:83], v[72:75], a[176:179], a[80:83]
    s_add_u32 m0, s21, 0
    v_exp_f32 v41, v41
    v_mfma_f32_16x16x32_bf16 a[112:115], v[76:79], a[176:179], a[112:115]
    v_cvt_pk_bf16_f32 v84, v40, v41
    v_mfma_f32_16x16x32_bf16 a[112:115], v[92:95], a[208:211], a[112:115]
    buffer_load_dwordx4 v188, s[4:7], s24 offen lds
    v_mfma_f32_16x16x32_bf16 a[116:119], v[92:95], a[212:215], a[116:119]
    v_exp_f32 v42, v42
    v_mfma_f32_16x16x32_bf16 a[116:119], v[76:79], a[180:183], a[116:119]
    v_exp_f32 v43, v43
    v_mfma_f32_16x16x32_bf16 a[84:87], v[72:75], a[180:183], a[84:87]
    v_cvt_pk_bf16_f32 v85, v42, v43
    v_mfma_f32_16x16x32_bf16 a[84:87], v[88:91], a[212:215], a[84:87]
    buffer_load_dwordx4 v189, s[4:7], s24 offen offset:1024 lds
    v_mfma_f32_16x16x32_bf16 a[88:91], v[88:91], a[216:219], a[88:91]
    s_add_u32 s24, s24, 8192
    v_exp_f32 v44, v44
    v_mfma_f32_16x16x32_bf16 a[88:91], v[72:75], a[184:187], a[88:91]
    s_add_u32 m0, s22, 49152
    v_exp_f32 v45, v45
    v_mfma_f32_16x16x32_bf16 a[120:123], v[76:79], a[184:187], a[120:123]
    s_and_b32 s24, s24, 0x7ffff
    v_cvt_pk_bf16_f32 v86, v44, v45
    v_mfma_f32_16x16x32_bf16 a[120:123], v[92:95], a[216:219], a[120:123]
    buffer_load_dwordx4 v190, s[8:11], s25 offen lds
    v_mfma_f32_16x16x32_bf16 a[124:127], v[92:95], a[220:223], a[124:127]
    s_waitcnt vmcnt(15)
    v_exp_f32 v46, v46
    v_mfma_f32_16x16x32_bf16 a[124:127], v[76:79], a[188:191], a[124:127]
    v_exp_f32 v47, v47
    v_mfma_f32_16x16x32_bf16 a[92:95], v[72:75], a[188:191], a[92:95]
    s_waitcnt lgkmcnt(0)
    v_cvt_pk_bf16_f32 v87, v46, v47
    v_mfma_f32_16x16x32_bf16 a[92:95], v[88:91], a[220:223], a[92:95]
    buffer_load_dwordx4 v191, s[8:11], s25 offen offset:1024 lds
    v_smfmac_f32_16x16x64_bf16 a[228:231], v[192:195], v[88:95], v196
    s_barrier
    v_smfmac_f32_16x16x64_bf16 a[228:231], v[192:195], v[72:79], v196
    v_mfma_f32_16x16x32_bf16 v[16:19], a[128:131], v[144:147], v[104:107]
    v_exp_f32 v48, v48
    v_mfma_f32_16x16x32_bf16 v[16:19], a[132:135], v[148:151], v[16:19]
    ds_read_b64_tr_b16 a[192:193], v180 offset:8192
    v_mfma_f32_16x16x32_bf16 v[16:19], a[136:139], v[152:155], v[16:19]
    v_exp_f32 v49, v49
    v_mfma_f32_16x16x32_bf16 v[16:19], a[140:143], v[156:159], v[16:19]
    ds_read_b64_tr_b16 a[194:195], v180 offset:12288
    v_cvt_pk_bf16_f32 v88, v48, v49
    v_mfma_f32_16x16x32_bf16 v[20:23], a[156:159], v[156:159], v[104:107]
    v_exp_f32 v50, v50
    v_mfma_f32_16x16x32_bf16 v[20:23], a[152:155], v[152:155], v[20:23]
    ds_read_b64_tr_b16 a[196:197], v181 offset:8192
    v_mfma_f32_16x16x32_bf16 v[20:23], a[148:151], v[148:151], v[20:23]
    v_exp_f32 v51, v51
    v_mfma_f32_16x16x32_bf16 v[20:23], a[144:147], v[144:147], v[20:23]
    ds_read_b64_tr_b16 a[198:199], v181 offset:12288
    v_cvt_pk_bf16_f32 v89, v50, v51
    v_mfma_f32_16x16x32_bf16 v[28:31], a[144:147], v[160:163], v[108:111]
    v_exp_f32 v52, v52
    v_mfma_f32_16x16x32_bf16 v[28:31], a[148:151], v[164:167], v[28:31]
    ds_read_b64_tr_b16 a[200:201], v182 offset:8192
    v_mfma_f32_16x16x32_bf16 v[28:31], a[152:155], v[168:171], v[28:31]
    v_exp_f32 v53, v53
    v_mfma_f32_16x16x32_bf16 v[28:31], a[156:159], v[172:175], v[28:31]
    ds_read_b64_tr_b16 a[202:203], v182 offset:12288
    v_cvt_pk_bf16_f32 v90, v52, v53
    v_mfma_f32_16x16x32_bf16 v[24:27], a[140:143], v[172:175], v[108:111]
    v_exp_f32 v54, v54
    v_mfma_f32_16x16x32_bf16 v[24:27], a[136:139], v[168:171], v[24:27]
    ds_read_b64_tr_b16 a[204:205], v183 offset:8192
    v_mfma_f32_16x16x32_bf16 v[24:27], a[132:135], v[164:167], v[24:27]
    v_exp_f32 v55, v55
    v_mfma_f32_16x16x32_bf16 v[24:27], a[128:131], v[160:163], v[24:27]
    ds_read_b64_tr_b16 a[206:207], v183 offset:12288
    v_cvt_pk_bf16_f32 v91, v54, v55
    v_mfma_f32_16x16x32_bf16 v[0:3], a[128:131], v[112:115], v[96:99]
    v_exp_f32 v56, v56
    v_mfma_f32_16x16x32_bf16 v[0:3], a[132:135], v[116:119], v[0:3]
    ds_read_b64_tr_b16 a[208:209], v184 offset:8192
    v_mfma_f32_16x16x32_bf16 v[0:3], a[136:139], v[120:123], v[0:3]
    v_exp_f32 v57, v57
    v_mfma_f32_16x16x32_bf16 v[0:3], a[140:143], v[124:127], v[0:3]
    ds_read_b64_tr_b16 a[210:211], v184 offset:12288
    v_cvt_pk_bf16_f32 v92, v56, v57
    v_mfma_f32_16x16x32_bf16 v[4:7], a[156:159], v[124:127], v[96:99]
    v_exp_f32 v58, v58
    v_mfma_f32_16x16x32_bf16 v[4:7], a[152:155], v[120:123], v[4:7]
    ds_read_b64_tr_b16 a[212:213], v185 offset:8192
    v_mfma_f32_16x16x32_bf16 v[4:7], a[148:151], v[116:119], v[4:7]
    v_exp_f32 v59, v59
    v_mfma_f32_16x16x32_bf16 v[4:7], a[144:147], v[112:115], v[4:7]
    ds_read_b64_tr_b16 a[214:215], v185 offset:12288
    v_cvt_pk_bf16_f32 v93, v58, v59
    v_mfma_f32_16x16x32_bf16 v[12:15], a[144:147], v[128:131], v[100:103]
    v_exp_f32 v60, v60
    v_mfma_f32_16x16x32_bf16 v[12:15], a[148:151], v[132:135], v[12:15]
    ds_read_b64_tr_b16 a[216:217], v186 offset:8192
    v_mfma_f32_16x16x32_bf16 v[12:15], a[152:155], v[136:139], v[12:15]
    v_exp_f32 v61, v61
    v_mfma_f32_16x16x32_bf16 v[12:15], a[156:159], v[140:143], v[12:15]
    ds_read_b64_tr_b16 a[218:219], v186 offset:12288
    v_cvt_pk_bf16_f32 v94, v60, v61
    v_mfma_f32_16x16x32_bf16 v[8:11], a[140:143], v[140:143], v[100:103]
    s_waitcnt lgkmcnt(6)
    v_exp_f32 v62, v62
    v_mfma_f32_16x16x32_bf16 v[8:11], a[136:139], v[136:139], v[8:11]
    ds_read_b64_tr_b16 a[220:221], v187 offset:8192
    v_mfma_f32_16x16x32_bf16 v[8:11], a[132:135], v[132:135], v[8:11]
    v_exp_f32 v63, v63
    v_mfma_f32_16x16x32_bf16 v[8:11], a[128:131], v[128:131], v[8:11]
    ds_read_b64_tr_b16 a[222:223], v187 offset:12288
    v_cvt_pk_bf16_f32 v95, v62, v63
    v_mfma_f32_16x16x32_bf16 a[0:3], v[64:67], a[160:163], a[0:3]
    v_exp_f32 v16, v16
    v_mfma_f32_16x16x32_bf16 a[0:3], v[80:83], a[192:195], a[0:3]
    ds_read_b128 a[128:131], v176 offset:24576
    v_mfma_f32_16x16x32_bf16 a[32:35], v[84:87], a[192:195], a[32:35]
    v_exp_f32 v17, v17
    v_mfma_f32_16x16x32_bf16 a[32:35], v[68:71], a[160:163], a[32:35]
    ds_read_b128 a[132:135], v177 offset:24576
    v_cvt_pk_bf16_f32 v72, v16, v17
    v_mfma_f32_16x16x32_bf16 a[36:39], v[68:71], a[164:167], a[36:39]
    v_exp_f32 v18, v18
    v_mfma_f32_16x16x32_bf16 a[36:39], v[84:87], a[196:199], a[36:39]
    ds_read_b128 a[136:139], v178 offset:24576
    v_mfma_f32_16x16x32_bf16 a[4:7], v[80:83], a[196:199], a[4:7]
    v_exp_f32 v19, v19
    v_mfma_f32_16x16x32_bf16 a[4:7], v[64:67], a[164:167], a[4:7]
    ds_read_b128 a[140:143], v179 offset:24576
    v_cvt_pk_bf16_f32 v73, v18, v19
    v_mfma_f32_16x16x32_bf16 a[8:11], v[64:67], a[168:171], a[8:11]
    s_add_u32 s25, s25, 8192
    v_exp_f32 v20, v20
    v_mfma_f32_16x16x32_bf16 a[8:11], v[80:83], a[200:203], a[8:11]
    ds_read_b128 a[144:147], v176 offset:28672
    v_mfma_f32_16x16x32_bf16 a[40:43], v[84:87], a[200:203], a[40:43]
    v_exp_f32 v21, v21
    v_mfma_f32_16x16x32_bf16 a[40:43], v[68:71], a[168:171], a[40:43]
    ds_read_b128 a[148:151], v177 offset:28672
    v_cvt_pk_bf16_f32 v74, v20, v21
    v_mfma_f32_16x16x32_bf16 a[44:47], v[68:71], a[172:175], a[44:47]
    s_waitcnt lgkmcnt(6)
    v_exp_f32 v22, v22
    v_mfma_f32_16x16x32_bf16 a[44:47], v[84:87], a[204:207], a[44:47]
    ds_read_b128 a[152:155], v178 offset:28672
    v_mfma_f32_16x16x32_bf16 a[12:15], v[80:83], a[204:207], a[12:15]
    v_exp_f32 v23, v23
    v_mfma_f32_16x16x32_bf16 a[12:15], v[64:67], a[172:175], a[12:15]
    ds_read_b128 a[156:159], v179 offset:28672
    v_cvt_pk_bf16_f32 v75, v22, v23
    v_mfma_f32_16x16x32_bf16 a[16:19], v[64:67], a[176:179], a[16:19]
    s_and_b32 s25, s25, 0x7ffff
    v_exp_f32 v24, v24
    v_mfma_f32_16x16x32_bf16 a[16:19], v[80:83], a[208:211], a[16:19]
    s_add_u32 m0, s21, 8192
    v_exp_f32 v25, v25
    v_mfma_f32_16x16x32_bf16 a[48:51], v[84:87], a[208:211], a[48:51]
    v_cvt_pk_bf16_f32 v76, v24, v25
    v_mfma_f32_16x16x32_bf16 a[48:51], v[68:71], a[176:179], a[48:51]
    buffer_load_dwordx4 v188, s[4:7], s24 offen lds
    v_mfma_f32_16x16x32_bf16 a[52:55], v[68:71], a[180:183], a[52:55]
    v_exp_f32 v26, v26
    v_mfma_f32_16x16x32_bf16 a[52:55], v[84:87], a[212:215], a[52:55]
    v_exp_f32 v27, v27
    v_mfma_f32_16x16x32_bf16 a[20:23], v[80:83], a[212:215], a[20:23]
    v_cvt_pk_bf16_f32 v77, v26, v27
    v_mfma_f32_16x16x32_bf16 a[20:23], v[64:67], a[180:183], a[20:23]
    buffer_load_dwordx4 v189, s[4:7], s24 offen offset:1024 lds
    v_mfma_f32_16x16x32_bf16 a[24:27], v[64:67], a[184:187], a[24:27]
    s_add_u32 s24, s24, 8192
    v_exp_f32 v28, v28
    v_mfma_f32_16x16x32_bf16 a[24:27], v[80:83], a[216:219], a[24:27]
    s_add_u32 m0, s22, 57344
    v_exp_f32 v29, v29
    v_mfma_f32_16x16x32_bf16 a[56:59], v[84:87], a[216:219], a[56:59]
    s_and_b32 s24, s24, 0x7ffff
    v_cvt_pk_bf16_f32 v78, v28, v29
    v_mfma_f32_16x16x32_bf16 a[56:59], v[68:71], a[184:187], a[56:59]
    buffer_load_dwordx4 v190, s[8:11], s25 offen lds
    v_mfma_f32_16x16x32_bf16 a[60:63], v[68:71], a[188:191], a[60:63]
    v_exp_f32 v30, v30
    v_mfma_f32_16x16x32_bf16 a[60:63], v[84:87], a[220:223], a[60:63]
    v_exp_f32 v31, v31
    v_mfma_f32_16x16x32_bf16 a[28:31], v[80:83], a[220:223], a[28:31]
    s_waitcnt lgkmcnt(0)
    v_cvt_pk_bf16_f32 v79, v30, v31
    v_mfma_f32_16x16x32_bf16 a[28:31], v[64:67], a[188:191], a[28:31]
    buffer_load_dwordx4 v191, s[8:11], s25 offen offset:1024 lds
    v_smfmac_f32_16x16x64_bf16 a[224:227], v[192:195], v[64:71], v196
    v_smfmac_f32_16x16x64_bf16 a[224:227], v[192:195], v[80:87], v196
    v_mfma_f32_16x16x32_bf16 v[32:35], a[128:131], v[112:115], v[96:99]
    v_exp_f32 v0, v0
    v_mfma_f32_16x16x32_bf16 v[32:35], a[132:135], v[116:119], v[32:35]
    ds_read_b64_tr_b16 a[160:161], v180 offset:16384
    v_mfma_f32_16x16x32_bf16 v[32:35], a[136:139], v[120:123], v[32:35]
    v_exp_f32 v1, v1
    v_mfma_f32_16x16x32_bf16 v[32:35], a[140:143], v[124:127], v[32:35]
    ds_read_b64_tr_b16 a[162:163], v180 offset:20480
    v_cvt_pk_bf16_f32 v64, v0, v1
    v_mfma_f32_16x16x32_bf16 v[36:39], a[156:159], v[124:127], v[96:99]
    v_exp_f32 v2, v2
    v_mfma_f32_16x16x32_bf16 v[36:39], a[152:155], v[120:123], v[36:39]
    ds_read_b64_tr_b16 a[164:165], v181 offset:16384
    v_mfma_f32_16x16x32_bf16 v[36:39], a[148:151], v[116:119], v[36:39]
    v_exp_f32 v3, v3
    v_mfma_f32_16x16x32_bf16 v[36:39], a[144:147], v[112:115], v[36:39]
    ds_read_b64_tr_b16 a[166:167], v181 offset:20480
    v_cvt_pk_bf16_f32 v65, v2, v3
    v_mfma_f32_16x16x32_bf16 v[44:47], a[144:147], v[128:131], v[100:103]
    v_exp_f32 v4, v4
    v_mfma_f32_16x16x32_bf16 v[44:47], a[148:151], v[132:135], v[44:47]
    ds_read_b64_tr_b16 a[168:169], v182 offset:16384
    v_mfma_f32_16x16x32_bf16 v[44:47], a[152:155], v[136:139], v[44:47]
    v_exp_f32 v5, v5
    v_mfma_f32_16x16x32_bf16 v[44:47], a[156:159], v[140:143], v[44:47]
    ds_read_b64_tr_b16 a[170:171], v182 offset:20480
    v_cvt_pk_bf16_f32 v66, v4, v5
    v_mfma_f32_16x16x32_bf16 v[40:43], a[140:143], v[140:143], v[100:103]
    v_exp_f32 v6, v6
    v_mfma_f32_16x16x32_bf16 v[40:43], a[136:139], v[136:139], v[40:43]
    ds_read_b64_tr_b16 a[172:173], v183 offset:16384
    v_mfma_f32_16x16x32_bf16 v[40:43], a[132:135], v[132:135], v[40:43]
    v_exp_f32 v7, v7
    v_mfma_f32_16x16x32_bf16 v[40:43], a[128:131], v[128:131], v[40:43]
    ds_read_b64_tr_b16 a[174:175], v183 offset:20480
    v_cvt_pk_bf16_f32 v67, v6, v7
    v_mfma_f32_16x16x32_bf16 v[48:51], a[128:131], v[144:147], v[104:107]
    v_exp_f32 v8, v8
    v_mfma_f32_16x16x32_bf16 v[48:51], a[132:135], v[148:151], v[48:51]
    ds_read_b64_tr_b16 a[176:177], v184 offset:16384
    v_mfma_f32_16x16x32_bf16 v[48:51], a[136:139], v[152:155], v[48:51]
    v_exp_f32 v9, v9
    v_mfma_f32_16x16x32_bf16 v[48:51], a[140:143], v[156:159], v[48:51]
    ds_read_b64_tr_b16 a[178:179], v184 offset:20480
    v_cvt_pk_bf16_f32 v68, v8, v9
    v_mfma_f32_16x16x32_bf16 v[52:55], a[156:159], v[156:159], v[104:107]
    v_exp_f32 v10, v10
    v_mfma_f32_16x16x32_bf16 v[52:55], a[152:155], v[152:155], v[52:55]
    ds_read_b64_tr_b16 a[180:181], v185 offset:16384
    v_mfma_f32_16x16x32_bf16 v[52:55], a[148:151], v[148:151], v[52:55]
    v_exp_f32 v11, v11
    v_mfma_f32_16x16x32_bf16 v[52:55], a[144:147], v[144:147], v[52:55]
    ds_read_b64_tr_b16 a[182:183], v185 offset:20480
    v_cvt_pk_bf16_f32 v69, v10, v11
    v_mfma_f32_16x16x32_bf16 v[60:63], a[144:147], v[160:163], v[108:111]
    v_exp_f32 v12, v12
    v_mfma_f32_16x16x32_bf16 v[60:63], a[148:151], v[164:167], v[60:63]
    ds_read_b64_tr_b16 a[184:185], v186 offset:16384
    v_mfma_f32_16x16x32_bf16 v[60:63], a[152:155], v[168:171], v[60:63]
    v_exp_f32 v13, v13
    v_mfma_f32_16x16x32_bf16 v[60:63], a[156:159], v[172:175], v[60:63]
    ds_read_b64_tr_b16 a[186:187], v186 offset:20480
    v_cvt_pk_bf16_f32 v70, v12, v13
    v_mfma_f32_16x16x32_bf16 v[56:59], a[140:143], v[172:175], v[108:111]
    s_waitcnt lgkmcnt(6)
    v_exp_f32 v14, v14
    v_mfma_f32_16x16x32_bf16 v[56:59], a[136:139], v[168:171], v[56:59]
    ds_read_b64_tr_b16 a[188:189], v187 offset:16384
    v_mfma_f32_16x16x32_bf16 v[56:59], a[132:135], v[164:167], v[56:59]
    v_exp_f32 v15, v15
    v_mfma_f32_16x16x32_bf16 v[56:59], a[128:131], v[160:163], v[56:59]
    ds_read_b64_tr_b16 a[190:191], v187 offset:20480
    v_cvt_pk_bf16_f32 v71, v14, v15
    v_mfma_f32_16x16x32_bf16 a[64:67], v[88:91], a[192:195], a[64:67]
    v_exp_f32 v32, v32
    v_mfma_f32_16x16x32_bf16 a[64:67], v[72:75], a[160:163], a[64:67]
    ds_read_b128 a[128:131], v176 offset:32768
    v_mfma_f32_16x16x32_bf16 a[96:99], v[76:79], a[160:163], a[96:99]
    v_exp_f32 v33, v33
    v_mfma_f32_16x16x32_bf16 a[96:99], v[92:95], a[192:195], a[96:99]
    ds_read_b128 a[132:135], v177 offset:32768
    v_cvt_pk_bf16_f32 v80, v32, v33
    v_mfma_f32_16x16x32_bf16 a[100:103], v[92:95], a[196:199], a[100:103]
    v_exp_f32 v34, v34
    v_mfma_f32_16x16x32_bf16 a[100:103], v[76:79], a[164:167], a[100:103]
    ds_read_b128 a[136:139], v178 offset:32768
    v_mfma_f32_16x16x32_bf16 a[68:71], v[72:75], a[164:167], a[68:71]
    v_exp_f32 v35, v35
    v_mfma_f32_16x16x32_bf16 a[68:71], v[88:91], a[196:199], a[68:71]
    ds_read_b128 a[140:143], v179 offset:32768
    v_cvt_pk_bf16_f32 v81, v34, v35
    v_mfma_f32_16x16x32_bf16 a[72:75], v[88:91], a[200:203], a[72:75]
    s_add_u32 s25, s25, 8192
    v_exp_f32 v36, v36
    v_mfma_f32_16x16x32_bf16 a[72:75], v[72:75], a[168:171], a[72:75]
    ds_read_b128 a[144:147], v176 offset:36864
    v_mfma_f32_16x16x32_bf16 a[104:107], v[76:79], a[168:171], a[104:107]
    v_exp_f32 v37, v37
    v_mfma_f32_16x16x32_bf16 a[104:107], v[92:95], a[200:203], a[104:107]
    ds_read_b128 a[148:151], v177 offset:36864
    v_cvt_pk_bf16_f32 v82, v36, v37
    v_mfma_f32_16x16x32_bf16 a[108:111], v[92:95], a[204:207], a[108:111]
    s_waitcnt lgkmcnt(6)
    v_exp_f32 v38, v38
    v_mfma_f32_16x16x32_bf16 a[108:111], v[76:79], a[172:175], a[108:111]
    ds_read_b128 a[152:155], v178 offset:36864
    v_mfma_f32_16x16x32_bf16 a[76:79], v[72:75], a[172:175], a[76:79]
    v_exp_f32 v39, v39
    v_mfma_f32_16x16x32_bf16 a[76:79], v[88:91], a[204:207], a[76:79]
    ds_read_b128 a[156:159], v179 offset:36864
    v_cvt_pk_bf16_f32 v83, v38, v39
    v_mfma_f32_16x16x32_bf16 a[80:83], v[88:91], a[208:211], a[80:83]
    s_and_b32 s25, s25, 0x7ffff
    v_exp_f32 v40, v40
    v_mfma_f32_16x16x32_bf16 a[80:83], v[72:75], a[176:179], a[80:83]
    s_add_u32 m0, s21, 16384
    v_exp_f32 v41, v41
    v_mfma_f32_16x16x32_bf16 a[112:115], v[76:79], a[176:179], a[112:115]
    v_cvt_pk_bf16_f32 v84, v40, v41
    v_mfma_f32_16x16x32_bf16 a[112:115], v[92:95], a[208:211], a[112:115]
    buffer_load_dwordx4 v188, s[4:7], s24 offen lds
    v_mfma_f32_16x16x32_bf16 a[116:119], v[92:95], a[212:215], a[116:119]
    v_exp_f32 v42, v42
    v_mfma_f32_16x16x32_bf16 a[116:119], v[76:79], a[180:183], a[116:119]
    v_exp_f32 v43, v43
    v_mfma_f32_16x16x32_bf16 a[84:87], v[72:75], a[180:183], a[84:87]
    v_cvt_pk_bf16_f32 v85, v42, v43
    v_mfma_f32_16x16x32_bf16 a[84:87], v[88:91], a[212:215], a[84:87]
    buffer_load_dwordx4 v189, s[4:7], s24 offen offset:1024 lds
    v_mfma_f32_16x16x32_bf16 a[88:91], v[88:91], a[216:219], a[88:91]
    s_add_u32 s24, s24, 8192
    v_exp_f32 v44, v44
    v_mfma_f32_16x16x32_bf16 a[88:91], v[72:75], a[184:187], a[88:91]
    s_add_u32 m0, s22, 0
    v_exp_f32 v45, v45
    v_mfma_f32_16x16x32_bf16 a[120:123], v[76:79], a[184:187], a[120:123]
    s_and_b32 s24, s24, 0x7ffff
    v_cvt_pk_bf16_f32 v86, v44, v45
    v_mfma_f32_16x16x32_bf16 a[120:123], v[92:95], a[216:219], a[120:123]
    buffer_load_dwordx4 v190, s[8:11], s25 offen lds
    v_mfma_f32_16x16x32_bf16 a[124:127], v[92:95], a[220:223], a[124:127]
    s_waitcnt vmcnt(15)
    v_exp_f32 v46, v46
    v_mfma_f32_16x16x32_bf16 a[124:127], v[76:79], a[188:191], a[124:127]
    v_exp_f32 v47, v47
    v_mfma_f32_16x16x32_bf16 a[92:95], v[72:75], a[188:191], a[92:95]
    s_waitcnt lgkmcnt(0)
    v_cvt_pk_bf16_f32 v87, v46, v47
    v_mfma_f32_16x16x32_bf16 a[92:95], v[88:91], a[220:223], a[92:95]
    buffer_load_dwordx4 v191, s[8:11], s25 offen offset:1024 lds
    v_smfmac_f32_16x16x64_bf16 a[228:231], v[192:195], v[88:95], v196
    s_barrier
    v_smfmac_f32_16x16x64_bf16 a[228:231], v[192:195], v[72:79], v196
    v_mfma_f32_16x16x32_bf16 v[16:19], a[128:131], v[144:147], v[104:107]
    v_exp_f32 v48, v48
    v_mfma_f32_16x16x32_bf16 v[16:19], a[132:135], v[148:151], v[16:19]
    ds_read_b64_tr_b16 a[192:193], v180 offset:24576
    v_mfma_f32_16x16x32_bf16 v[16:19], a[136:139], v[152:155], v[16:19]
    v_exp_f32 v49, v49
    v_mfma_f32_16x16x32_bf16 v[16:19], a[140:143], v[156:159], v[16:19]
    ds_read_b64_tr_b16 a[194:195], v180 offset:28672
    v_cvt_pk_bf16_f32 v88, v48, v49
    v_mfma_f32_16x16x32_bf16 v[20:23], a[156:159], v[156:159], v[104:107]
    v_exp_f32 v50, v50
    v_mfma_f32_16x16x32_bf16 v[20:23], a[152:155], v[152:155], v[20:23]
    ds_read_b64_tr_b16 a[196:197], v181 offset:24576
    v_mfma_f32_16x16x32_bf16 v[20:23], a[148:151], v[148:151], v[20:23]
    v_exp_f32 v51, v51
    v_mfma_f32_16x16x32_bf16 v[20:23], a[144:147], v[144:147], v[20:23]
    ds_read_b64_tr_b16 a[198:199], v181 offset:28672
    v_cvt_pk_bf16_f32 v89, v50, v51
    v_mfma_f32_16x16x32_bf16 v[28:31], a[144:147], v[160:163], v[108:111]
    v_exp_f32 v52, v52
    v_mfma_f32_16x16x32_bf16 v[28:31], a[148:151], v[164:167], v[28:31]
    ds_read_b64_tr_b16 a[200:201], v182 offset:24576
    v_mfma_f32_16x16x32_bf16 v[28:31], a[152:155], v[168:171], v[28:31]
    v_exp_f32 v53, v53
    v_mfma_f32_16x16x32_bf16 v[28:31], a[156:159], v[172:175], v[28:31]
    ds_read_b64_tr_b16 a[202:203], v182 offset:28672
    v_cvt_pk_bf16_f32 v90, v52, v53
    v_mfma_f32_16x16x32_bf16 v[24:27], a[140:143], v[172:175], v[108:111]
    v_exp_f32 v54, v54
    v_mfma_f32_16x16x32_bf16 v[24:27], a[136:139], v[168:171], v[24:27]
    ds_read_b64_tr_b16 a[204:205], v183 offset:24576
    v_mfma_f32_16x16x32_bf16 v[24:27], a[132:135], v[164:167], v[24:27]
    v_exp_f32 v55, v55
    v_mfma_f32_16x16x32_bf16 v[24:27], a[128:131], v[160:163], v[24:27]
    ds_read_b64_tr_b16 a[206:207], v183 offset:28672
    v_cvt_pk_bf16_f32 v91, v54, v55
    v_mfma_f32_16x16x32_bf16 v[0:3], a[128:131], v[112:115], v[96:99]
    v_exp_f32 v56, v56
    v_mfma_f32_16x16x32_bf16 v[0:3], a[132:135], v[116:119], v[0:3]
    ds_read_b64_tr_b16 a[208:209], v184 offset:24576
    v_mfma_f32_16x16x32_bf16 v[0:3], a[136:139], v[120:123], v[0:3]
    v_exp_f32 v57, v57
    v_mfma_f32_16x16x32_bf16 v[0:3], a[140:143], v[124:127], v[0:3]
    ds_read_b64_tr_b16 a[210:211], v184 offset:28672
    v_cvt_pk_bf16_f32 v92, v56, v57
    v_mfma_f32_16x16x32_bf16 v[4:7], a[156:159], v[124:127], v[96:99]
    v_exp_f32 v58, v58
    v_mfma_f32_16x16x32_bf16 v[4:7], a[152:155], v[120:123], v[4:7]
    ds_read_b64_tr_b16 a[212:213], v185 offset:24576
    v_mfma_f32_16x16x32_bf16 v[4:7], a[148:151], v[116:119], v[4:7]
    v_exp_f32 v59, v59
    v_mfma_f32_16x16x32_bf16 v[4:7], a[144:147], v[112:115], v[4:7]
    ds_read_b64_tr_b16 a[214:215], v185 offset:28672
    v_cvt_pk_bf16_f32 v93, v58, v59
    v_mfma_f32_16x16x32_bf16 v[12:15], a[144:147], v[128:131], v[100:103]
    v_exp_f32 v60, v60
    v_mfma_f32_16x16x32_bf16 v[12:15], a[148:151], v[132:135], v[12:15]
    ds_read_b64_tr_b16 a[216:217], v186 offset:24576
    v_mfma_f32_16x16x32_bf16 v[12:15], a[152:155], v[136:139], v[12:15]
    v_exp_f32 v61, v61
    v_mfma_f32_16x16x32_bf16 v[12:15], a[156:159], v[140:143], v[12:15]
    ds_read_b64_tr_b16 a[218:219], v186 offset:28672
    v_cvt_pk_bf16_f32 v94, v60, v61
    v_mfma_f32_16x16x32_bf16 v[8:11], a[140:143], v[140:143], v[100:103]
    s_waitcnt lgkmcnt(6)
    v_exp_f32 v62, v62
    v_mfma_f32_16x16x32_bf16 v[8:11], a[136:139], v[136:139], v[8:11]
    ds_read_b64_tr_b16 a[220:221], v187 offset:24576
    v_mfma_f32_16x16x32_bf16 v[8:11], a[132:135], v[132:135], v[8:11]
    v_exp_f32 v63, v63
    v_mfma_f32_16x16x32_bf16 v[8:11], a[128:131], v[128:131], v[8:11]
    ds_read_b64_tr_b16 a[222:223], v187 offset:28672
    v_cvt_pk_bf16_f32 v95, v62, v63
    v_mfma_f32_16x16x32_bf16 a[0:3], v[64:67], a[160:163], a[0:3]
    v_exp_f32 v16, v16
    v_mfma_f32_16x16x32_bf16 a[0:3], v[80:83], a[192:195], a[0:3]
    ds_read_b128 a[128:131], v176 offset:40960
    v_mfma_f32_16x16x32_bf16 a[32:35], v[84:87], a[192:195], a[32:35]
    v_exp_f32 v17, v17
    v_mfma_f32_16x16x32_bf16 a[32:35], v[68:71], a[160:163], a[32:35]
    ds_read_b128 a[132:135], v177 offset:40960
    v_cvt_pk_bf16_f32 v72, v16, v17
    v_mfma_f32_16x16x32_bf16 a[36:39], v[68:71], a[164:167], a[36:39]
    v_exp_f32 v18, v18
    v_mfma_f32_16x16x32_bf16 a[36:39], v[84:87], a[196:199], a[36:39]
    ds_read_b128 a[136:139], v178 offset:40960
    v_mfma_f32_16x16x32_bf16 a[4:7], v[80:83], a[196:199], a[4:7]
    v_exp_f32 v19, v19
    v_mfma_f32_16x16x32_bf16 a[4:7], v[64:67], a[164:167], a[4:7]
    ds_read_b128 a[140:143], v179 offset:40960
    v_cvt_pk_bf16_f32 v73, v18, v19
    v_mfma_f32_16x16x32_bf16 a[8:11], v[64:67], a[168:171], a[8:11]
    s_add_u32 s25, s25, 8192
    v_exp_f32 v20, v20
    v_mfma_f32_16x16x32_bf16 a[8:11], v[80:83], a[200:203], a[8:11]
    ds_read_b128 a[144:147], v176 offset:45056
    v_mfma_f32_16x16x32_bf16 a[40:43], v[84:87], a[200:203], a[40:43]
    v_exp_f32 v21, v21
    v_mfma_f32_16x16x32_bf16 a[40:43], v[68:71], a[168:171], a[40:43]
    ds_read_b128 a[148:151], v177 offset:45056
    v_cvt_pk_bf16_f32 v74, v20, v21
    v_mfma_f32_16x16x32_bf16 a[44:47], v[68:71], a[172:175], a[44:47]
    s_waitcnt lgkmcnt(6)
    v_exp_f32 v22, v22
    v_mfma_f32_16x16x32_bf16 a[44:47], v[84:87], a[204:207], a[44:47]
    ds_read_b128 a[152:155], v178 offset:45056
    v_mfma_f32_16x16x32_bf16 a[12:15], v[80:83], a[204:207], a[12:15]
    v_exp_f32 v23, v23
    v_mfma_f32_16x16x32_bf16 a[12:15], v[64:67], a[172:175], a[12:15]
    ds_read_b128 a[156:159], v179 offset:45056
    v_cvt_pk_bf16_f32 v75, v22, v23
    v_mfma_f32_16x16x32_bf16 a[16:19], v[64:67], a[176:179], a[16:19]
    s_and_b32 s25, s25, 0x7ffff
    v_exp_f32 v24, v24
    v_mfma_f32_16x16x32_bf16 a[16:19], v[80:83], a[208:211], a[16:19]
    s_add_u32 m0, s21, 24576
    v_exp_f32 v25, v25
    v_mfma_f32_16x16x32_bf16 a[48:51], v[84:87], a[208:211], a[48:51]
    v_cvt_pk_bf16_f32 v76, v24, v25
    v_mfma_f32_16x16x32_bf16 a[48:51], v[68:71], a[176:179], a[48:51]
    buffer_load_dwordx4 v188, s[4:7], s24 offen lds
    v_mfma_f32_16x16x32_bf16 a[52:55], v[68:71], a[180:183], a[52:55]
    v_exp_f32 v26, v26
    v_mfma_f32_16x16x32_bf16 a[52:55], v[84:87], a[212:215], a[52:55]
    v_exp_f32 v27, v27
    v_mfma_f32_16x16x32_bf16 a[20:23], v[80:83], a[212:215], a[20:23]
    v_cvt_pk_bf16_f32 v77, v26, v27
    v_mfma_f32_16x16x32_bf16 a[20:23], v[64:67], a[180:183], a[20:23]
    buffer_load_dwordx4 v189, s[4:7], s24 offen offset:1024 lds
    v_mfma_f32_16x16x32_bf16 a[24:27], v[64:67], a[184:187], a[24:27]
    s_add_u32 s24, s24, 8192
    v_exp_f32 v28, v28
    v_mfma_f32_16x16x32_bf16 a[24:27], v[80:83], a[216:219], a[24:27]
    s_add_u32 m0, s22, 8192
    v_exp_f32 v29, v29
    v_mfma_f32_16x16x32_bf16 a[56:59], v[84:87], a[216:219], a[56:59]
    s_and_b32 s24, s24, 0x7ffff
    v_cvt_pk_bf16_f32 v78, v28, v29
    v_mfma_f32_16x16x32_bf16 a[56:59], v[68:71], a[184:187], a[56:59]
    buffer_load_dwordx4 v190, s[8:11], s25 offen lds
    v_mfma_f32_16x16x32_bf16 a[60:63], v[68:71], a[188:191], a[60:63]
    v_exp_f32 v30, v30
    v_mfma_f32_16x16x32_bf16 a[60:63], v[84:87], a[220:223], a[60:63]
    v_exp_f32 v31, v31
    v_mfma_f32_16x16x32_bf16 a[28:31], v[80:83], a[220:223], a[28:31]
    s_waitcnt lgkmcnt(0)
    v_cvt_pk_bf16_f32 v79, v30, v31
    v_mfma_f32_16x16x32_bf16 a[28:31], v[64:67], a[188:191], a[28:31]
    buffer_load_dwordx4 v191, s[8:11], s25 offen offset:1024 lds
    v_smfmac_f32_16x16x64_bf16 a[224:227], v[192:195], v[64:71], v196
    v_smfmac_f32_16x16x64_bf16 a[224:227], v[192:195], v[80:87], v196
    v_mfma_f32_16x16x32_bf16 v[32:35], a[128:131], v[112:115], v[96:99]
    v_exp_f32 v0, v0
    v_mfma_f32_16x16x32_bf16 v[32:35], a[132:135], v[116:119], v[32:35]
    ds_read_b64_tr_b16 a[160:161], v180 offset:32768
    v_mfma_f32_16x16x32_bf16 v[32:35], a[136:139], v[120:123], v[32:35]
    v_exp_f32 v1, v1
    v_mfma_f32_16x16x32_bf16 v[32:35], a[140:143], v[124:127], v[32:35]
    ds_read_b64_tr_b16 a[162:163], v180 offset:36864
    v_cvt_pk_bf16_f32 v64, v0, v1
    v_mfma_f32_16x16x32_bf16 v[36:39], a[156:159], v[124:127], v[96:99]
    v_exp_f32 v2, v2
    v_mfma_f32_16x16x32_bf16 v[36:39], a[152:155], v[120:123], v[36:39]
    ds_read_b64_tr_b16 a[164:165], v181 offset:32768
    v_mfma_f32_16x16x32_bf16 v[36:39], a[148:151], v[116:119], v[36:39]
    v_exp_f32 v3, v3
    v_mfma_f32_16x16x32_bf16 v[36:39], a[144:147], v[112:115], v[36:39]
    ds_read_b64_tr_b16 a[166:167], v181 offset:36864
    v_cvt_pk_bf16_f32 v65, v2, v3
    v_mfma_f32_16x16x32_bf16 v[44:47], a[144:147], v[128:131], v[100:103]
    v_exp_f32 v4, v4
    v_mfma_f32_16x16x32_bf16 v[44:47], a[148:151], v[132:135], v[44:47]
    ds_read_b64_tr_b16 a[168:169], v182 offset:32768
    v_mfma_f32_16x16x32_bf16 v[44:47], a[152:155], v[136:139], v[44:47]
    v_exp_f32 v5, v5
    v_mfma_f32_16x16x32_bf16 v[44:47], a[156:159], v[140:143], v[44:47]
    ds_read_b64_tr_b16 a[170:171], v182 offset:36864
    v_cvt_pk_bf16_f32 v66, v4, v5
    v_mfma_f32_16x16x32_bf16 v[40:43], a[140:143], v[140:143], v[100:103]
    v_exp_f32 v6, v6
    v_mfma_f32_16x16x32_bf16 v[40:43], a[136:139], v[136:139], v[40:43]
    ds_read_b64_tr_b16 a[172:173], v183 offset:32768
    v_mfma_f32_16x16x32_bf16 v[40:43], a[132:135], v[132:135], v[40:43]
    v_exp_f32 v7, v7
    v_mfma_f32_16x16x32_bf16 v[40:43], a[128:131], v[128:131], v[40:43]
    ds_read_b64_tr_b16 a[174:175], v183 offset:36864
    v_cvt_pk_bf16_f32 v67, v6, v7
    v_mfma_f32_16x16x32_bf16 v[48:51], a[128:131], v[144:147], v[104:107]
    v_exp_f32 v8, v8
    v_mfma_f32_16x16x32_bf16 v[48:51], a[132:135], v[148:151], v[48:51]
    ds_read_b64_tr_b16 a[176:177], v184 offset:32768
    v_mfma_f32_16x16x32_bf16 v[48:51], a[136:139], v[152:155], v[48:51]
    v_exp_f32 v9, v9
    v_mfma_f32_16x16x32_bf16 v[48:51], a[140:143], v[156:159], v[48:51]
    ds_read_b64_tr_b16 a[178:179], v184 offset:36864
    v_cvt_pk_bf16_f32 v68, v8, v9
    v_mfma_f32_16x16x32_bf16 v[52:55], a[156:159], v[156:159], v[104:107]
    v_exp_f32 v10, v10
    v_mfma_f32_16x16x32_bf16 v[52:55], a[152:155], v[152:155], v[52:55]
    ds_read_b64_tr_b16 a[180:181], v185 offset:32768
    v_mfma_f32_16x16x32_bf16 v[52:55], a[148:151], v[148:151], v[52:55]
    v_exp_f32 v11, v11
    v_mfma_f32_16x16x32_bf16 v[52:55], a[144:147], v[144:147], v[52:55]
    ds_read_b64_tr_b16 a[182:183], v185 offset:36864
    v_cvt_pk_bf16_f32 v69, v10, v11
    v_mfma_f32_16x16x32_bf16 v[60:63], a[144:147], v[160:163], v[108:111]
    v_exp_f32 v12, v12
    v_mfma_f32_16x16x32_bf16 v[60:63], a[148:151], v[164:167], v[60:63]
    ds_read_b64_tr_b16 a[184:185], v186 offset:32768
    v_mfma_f32_16x16x32_bf16 v[60:63], a[152:155], v[168:171], v[60:63]
    v_exp_f32 v13, v13
    v_mfma_f32_16x16x32_bf16 v[60:63], a[156:159], v[172:175], v[60:63]
    ds_read_b64_tr_b16 a[186:187], v186 offset:36864
    v_cvt_pk_bf16_f32 v70, v12, v13
    v_mfma_f32_16x16x32_bf16 v[56:59], a[140:143], v[172:175], v[108:111]
    s_waitcnt lgkmcnt(6)
    v_exp_f32 v14, v14
    v_mfma_f32_16x16x32_bf16 v[56:59], a[136:139], v[168:171], v[56:59]
    ds_read_b64_tr_b16 a[188:189], v187 offset:32768
    v_mfma_f32_16x16x32_bf16 v[56:59], a[132:135], v[164:167], v[56:59]
    v_exp_f32 v15, v15
    v_mfma_f32_16x16x32_bf16 v[56:59], a[128:131], v[160:163], v[56:59]
    ds_read_b64_tr_b16 a[190:191], v187 offset:36864
    v_cvt_pk_bf16_f32 v71, v14, v15
    v_mfma_f32_16x16x32_bf16 a[64:67], v[88:91], a[192:195], a[64:67]
    v_exp_f32 v32, v32
    v_mfma_f32_16x16x32_bf16 a[64:67], v[72:75], a[160:163], a[64:67]
    ds_read_b128 a[128:131], v176 offset:49152
    v_mfma_f32_16x16x32_bf16 a[96:99], v[76:79], a[160:163], a[96:99]
    v_exp_f32 v33, v33
    v_mfma_f32_16x16x32_bf16 a[96:99], v[92:95], a[192:195], a[96:99]
    ds_read_b128 a[132:135], v177 offset:49152
    v_cvt_pk_bf16_f32 v80, v32, v33
    v_mfma_f32_16x16x32_bf16 a[100:103], v[92:95], a[196:199], a[100:103]
    v_exp_f32 v34, v34
    v_mfma_f32_16x16x32_bf16 a[100:103], v[76:79], a[164:167], a[100:103]
    ds_read_b128 a[136:139], v178 offset:49152
    v_mfma_f32_16x16x32_bf16 a[68:71], v[72:75], a[164:167], a[68:71]
    v_exp_f32 v35, v35
    v_mfma_f32_16x16x32_bf16 a[68:71], v[88:91], a[196:199], a[68:71]
    ds_read_b128 a[140:143], v179 offset:49152
    v_cvt_pk_bf16_f32 v81, v34, v35
    v_mfma_f32_16x16x32_bf16 a[72:75], v[88:91], a[200:203], a[72:75]
    s_add_u32 s25, s25, 8192
    v_exp_f32 v36, v36
    v_mfma_f32_16x16x32_bf16 a[72:75], v[72:75], a[168:171], a[72:75]
    ds_read_b128 a[144:147], v176 offset:53248
    v_mfma_f32_16x16x32_bf16 a[104:107], v[76:79], a[168:171], a[104:107]
    v_exp_f32 v37, v37
    v_mfma_f32_16x16x32_bf16 a[104:107], v[92:95], a[200:203], a[104:107]
    ds_read_b128 a[148:151], v177 offset:53248
    v_cvt_pk_bf16_f32 v82, v36, v37
    v_mfma_f32_16x16x32_bf16 a[108:111], v[92:95], a[204:207], a[108:111]
    s_waitcnt lgkmcnt(6)
    v_exp_f32 v38, v38
    v_mfma_f32_16x16x32_bf16 a[108:111], v[76:79], a[172:175], a[108:111]
    ds_read_b128 a[152:155], v178 offset:53248
    v_mfma_f32_16x16x32_bf16 a[76:79], v[72:75], a[172:175], a[76:79]
    v_exp_f32 v39, v39
    v_mfma_f32_16x16x32_bf16 a[76:79], v[88:91], a[204:207], a[76:79]
    ds_read_b128 a[156:159], v179 offset:53248
    v_cvt_pk_bf16_f32 v83, v38, v39
    v_mfma_f32_16x16x32_bf16 a[80:83], v[88:91], a[208:211], a[80:83]
    s_and_b32 s25, s25, 0x7ffff
    v_exp_f32 v40, v40
    v_mfma_f32_16x16x32_bf16 a[80:83], v[72:75], a[176:179], a[80:83]
    s_add_u32 m0, s21, 32768
    v_exp_f32 v41, v41
    v_mfma_f32_16x16x32_bf16 a[112:115], v[76:79], a[176:179], a[112:115]
    v_cvt_pk_bf16_f32 v84, v40, v41
    v_mfma_f32_16x16x32_bf16 a[112:115], v[92:95], a[208:211], a[112:115]
    buffer_load_dwordx4 v188, s[4:7], s24 offen lds
    v_mfma_f32_16x16x32_bf16 a[116:119], v[92:95], a[212:215], a[116:119]
    s_add_u32 s26, s26, 1
    v_exp_f32 v42, v42
    v_mfma_f32_16x16x32_bf16 a[116:119], v[76:79], a[180:183], a[116:119]
    v_exp_f32 v43, v43
    v_mfma_f32_16x16x32_bf16 a[84:87], v[72:75], a[180:183], a[84:87]
    v_cvt_pk_bf16_f32 v85, v42, v43
    v_mfma_f32_16x16x32_bf16 a[84:87], v[88:91], a[212:215], a[84:87]
    buffer_load_dwordx4 v189, s[4:7], s24 offen offset:1024 lds
    v_mfma_f32_16x16x32_bf16 a[88:91], v[88:91], a[216:219], a[88:91]
    s_add_u32 s24, s24, 8192
    v_exp_f32 v44, v44
    v_mfma_f32_16x16x32_bf16 a[88:91], v[72:75], a[184:187], a[88:91]
    s_add_u32 m0, s22, 16384
    v_exp_f32 v45, v45
    v_mfma_f32_16x16x32_bf16 a[120:123], v[76:79], a[184:187], a[120:123]
    s_and_b32 s24, s24, 0x7ffff
    v_cvt_pk_bf16_f32 v86, v44, v45
    v_mfma_f32_16x16x32_bf16 a[120:123], v[92:95], a[216:219], a[120:123]
    buffer_load_dwordx4 v190, s[8:11], s25 offen lds
    v_mfma_f32_16x16x32_bf16 a[124:127], v[92:95], a[220:223], a[124:127]
    s_waitcnt vmcnt(15)
    v_exp_f32 v46, v46
    v_mfma_f32_16x16x32_bf16 a[124:127], v[76:79], a[188:191], a[124:127]
    v_exp_f32 v47, v47
    v_mfma_f32_16x16x32_bf16 a[92:95], v[72:75], a[188:191], a[92:95]
    s_waitcnt lgkmcnt(0)
    v_cvt_pk_bf16_f32 v87, v46, v47
    v_mfma_f32_16x16x32_bf16 a[92:95], v[88:91], a[220:223], a[92:95]
    buffer_load_dwordx4 v191, s[8:11], s25 offen offset:1024 lds
    v_smfmac_f32_16x16x64_bf16 a[228:231], v[192:195], v[88:95], v196
    s_barrier
    v_smfmac_f32_16x16x64_bf16 a[228:231], v[192:195], v[72:79], v196
    s_branch L_loop
L_tail:
    s_add_u32 s25, s25, 8192
    s_and_b32 s25, s25, 0x7ffff
    v_smfmac_f32_16x16x64_bf16 a[224:227], v[192:195], v[64:71], v196
    ds_read_b64_tr_b16 a[204:205], v183 offset:57344
    ds_read_b64_tr_b16 a[206:207], v183 offset:61440
    v_smfmac_f32_16x16x64_bf16 a[224:227], v[192:195], v[80:87], v196
    ds_read_b64_tr_b16 a[192:193], v180 offset:57344
    ds_read_b64_tr_b16 a[194:195], v180 offset:61440
    v_mfma_f32_16x16x32_bf16 v[16:19], a[128:131], v[144:147], v[104:107]
    ds_read_b64_tr_b16 a[202:203], v182 offset:61440
    ds_read_b64_tr_b16 a[198:199], v181 offset:61440
    v_mfma_f32_16x16x32_bf16 v[16:19], a[132:135], v[148:151], v[16:19]
    ds_read_b64_tr_b16 a[218:219], v186 offset:61440
    ds_read_b64_tr_b16 a[196:197], v181 offset:57344
    v_mfma_f32_16x16x32_bf16 v[16:19], a[136:139], v[152:155], v[16:19]
    ds_read_b64_tr_b16 a[216:217], v186 offset:57344
    v_exp_f32 v59, v59
    v_mfma_f32_16x16x32_bf16 v[16:19], a[140:143], v[156:159], v[16:19]
    ds_read_b64_tr_b16 a[200:201], v182 offset:57344
    v_accvgpr_read_b32 v250, a224
    v_mfma_f32_16x16x32_bf16 a[0:3], v[64:67], a[160:163], a[0:3]
    ds_read_b64_tr_b16 a[214:215], v185 offset:61440
    v_accvgpr_read_b32 v251, a225
    s_waitcnt lgkmcnt(7)
    v_mfma_f32_16x16x32_bf16 a[0:3], v[80:83], a[192:195], a[0:3]
    ds_read_b64_tr_b16 a[208:209], v184 offset:57344
    v_add_f32 v251, v250, v251
    v_mfma_f32_16x16x32_bf16 a[12:15], v[80:83], a[204:207], a[12:15]
    ds_read_b64_tr_b16 a[222:223], v187 offset:61440
    v_exp_f32 v56, v56
    v_mfma_f32_16x16x32_bf16 a[12:15], v[64:67], a[172:175], a[12:15]
    v_rcp_f32 v250, v251
    v_mfma_f32_16x16x32_bf16 a[8:11], v[64:67], a[168:171], a[8:11]
    v_accvgpr_read_b32 v233, a1
    s_waitcnt lgkmcnt(3)
    v_mfma_f32_16x16x32_bf16 a[8:11], v[80:83], a[200:203], a[8:11]
    ds_read_b64_tr_b16 a[220:221], v187 offset:57344
    v_accvgpr_read_b32 v232, a0
    v_accvgpr_read_b32 v234, a2
    v_mfma_f32_16x16x32_bf16 a[4:7], v[80:83], a[196:199], a[4:7]
    v_accvgpr_read_b32 v235, a3
    v_mfma_f32_16x16x32_bf16 a[4:7], v[64:67], a[164:167], a[4:7]
    ds_read_b64_tr_b16 a[210:211], v184 offset:61440
    v_accvgpr_read_b32 v245, a13
    v_accvgpr_read_b32 v247, a15
    v_mfma_f32_16x16x4_f32 v[96:99], v250, v199, 0
    ds_read_b64_tr_b16 a[212:213], v185 offset:57344
    v_accvgpr_read_b32 v244, a12
    v_accvgpr_read_b32 v241, a9
    v_accvgpr_read_b32 v242, a10
    v_accvgpr_read_b32 v246, a14
    v_mfma_f32_16x16x32_bf16 v[24:27], a[140:143], v[172:175], v[108:111]
    ds_read_b128 a[140:143], v179 offset:8192
    v_accvgpr_read_b32 v237, a5
    v_accvgpr_read_b32 v240, a8
    v_accvgpr_read_b32 v239, a7
    v_accvgpr_read_b32 v238, a6
    v_accvgpr_read_b32 v243, a11
    v_pk_mul_f32 v[216:217], v[216:217], v[96:97]
    v_pk_fma_f32 v[232:233], v[232:233], v[96:97], v[216:217] neg_lo:[0,0,1] neg_hi:[0,0,1]
    v_pk_fma_f32 v[240:241], v[240:241], v[96:97], v[216:217] neg_lo:[0,0,1] neg_hi:[0,0,1]
    v_pk_mul_f32 v[218:219], v[218:219], v[98:99]
    v_pk_fma_f32 v[244:245], v[244:245], v[96:97], v[216:217] neg_lo:[0,0,1] neg_hi:[0,0,1]
    v_pk_fma_f32 v[242:243], v[242:243], v[98:99], v[218:219] neg_lo:[0,0,1] neg_hi:[0,0,1]
    v_accvgpr_read_b32 v236, a4
    v_pk_fma_f32 v[236:237], v[236:237], v[96:97], v[216:217] neg_lo:[0,0,1] neg_hi:[0,0,1]
    v_cvt_pk_bf16_f32 v1, v240, v244
    v_cvt_pk_bf16_f32 v0, v232, v236
    v_pk_fma_f32 v[238:239], v[238:239], v[98:99], v[218:219] neg_lo:[0,0,1] neg_hi:[0,0,1]
    v_pk_fma_f32 v[246:247], v[246:247], v[98:99], v[218:219] neg_lo:[0,0,1] neg_hi:[0,0,1]
    v_pk_fma_f32 v[234:235], v[234:235], v[98:99], v[218:219] neg_lo:[0,0,1] neg_hi:[0,0,1]
    s_waitcnt lgkmcnt(0)
    v_mfma_f32_16x16x32_bf16 a[28:31], v[80:83], a[220:223], a[28:31]
    ds_write_b64 v208, v[0:1] offset:0
    v_cvt_pk_bf16_f32 v2, v233, v237
    v_cvt_pk_bf16_f32 v3, v241, v245
    v_mfma_f32_16x16x32_bf16 a[28:31], v[64:67], a[188:191], a[28:31]
    ds_write_b64 v209, v[2:3] offset:256
    v_cvt_pk_bf16_f32 v4, v234, v238
    v_mfma_f32_16x16x32_bf16 a[24:27], v[64:67], a[184:187], a[24:27]
    v_cvt_pk_bf16_f32 v5, v242, v246
    v_mfma_f32_16x16x32_bf16 a[24:27], v[80:83], a[216:219], a[24:27]
    ds_write_b64 v208, v[4:5] offset:640
    v_cvt_pk_bf16_f32 v6, v235, v239
    v_cvt_pk_bf16_f32 v7, v243, v247
    v_mfma_f32_16x16x32_bf16 a[36:39], v[68:71], a[164:167], a[36:39]
    ds_write_b64 v209, v[6:7] offset:896
    v_subrev_u32 v251, 0x2b800000, v251
    v_mfma_f32_16x16x32_bf16 a[16:19], v[64:67], a[176:179], a[16:19]
    ds_read_b64_tr_b16 v[0:1], v210 offset:0
    v_accvgpr_read_b32 v242, a26
    v_accvgpr_read_b32 v243, a27
    v_mfma_f32_16x16x32_bf16 a[16:19], v[80:83], a[208:211], a[16:19]
    ds_read_b64_tr_b16 v[2:3], v211 offset:0
    v_cmp_le_u32 vcc, s45, v251
    v_accvgpr_read_b32 v244, a28
    v_mfma_f32_16x16x32_bf16 a[20:23], v[80:83], a[212:215], a[20:23]
    ds_read_b64_tr_b16 v[4:5], v210 offset:2048
    v_exp_f32 v53, v53
    v_accvgpr_read_b32 v241, a25
    v_mfma_f32_16x16x32_bf16 a[20:23], v[64:67], a[180:183], a[20:23]
    ds_read_b64_tr_b16 v[6:7], v211 offset:2048
    v_accvgpr_read_b32 v234, a18
    v_accvgpr_read_b32 v245, a29
    v_mfma_f32_16x16x32_bf16 a[44:47], v[68:71], a[172:175], a[44:47]
    ds_read_b64_tr_b16 a[164:165], v181 offset:0
    v_accvgpr_read_b32 v233, a17
    v_accvgpr_read_b32 v240, a24
    v_mfma_f32_16x16x32_bf16 a[32:35], v[84:87], a[192:195], a[32:35]
    s_waitcnt lgkmcnt(3)
    buffer_store_dwordx4 v[0:3], v248, s[16:19], 0 offen sc1
    v_mfma_f32_16x16x32_bf16 a[32:35], v[68:71], a[160:163], a[32:35]
    ds_read_b64_tr_b16 a[172:173], v183 offset:0
    v_accvgpr_read_b32 v247, a31
    v_accvgpr_read_b32 v232, a16
    v_accvgpr_read_b32 v246, a30
    v_mfma_f32_16x16x32_bf16 v[24:27], a[136:139], v[168:171], v[24:27]
    ds_read_b64_tr_b16 a[160:161], v180 offset:0
    v_accvgpr_read_b32 v235, a19
    v_accvgpr_read_b32 v251, a227
    v_mfma_f32_16x16x32_bf16 v[24:27], a[132:135], v[164:167], v[24:27]
    ds_read_b128 a[132:135], v177 offset:8192
    v_accvgpr_read_b32 v239, a23
    v_accvgpr_read_b32 v237, a21
    v_mfma_f32_16x16x32_bf16 v[24:27], a[128:131], v[160:163], v[24:27]
    s_waitcnt lgkmcnt(3)
    buffer_store_dwordx4 v[4:7], v248, s[16:19], 0 offen offset:2048 sc1
    v_mfma_f32_16x16x32_bf16 a[44:47], v[84:87], a[204:207], a[44:47]
    ds_read_b64_tr_b16 a[174:175], v183 offset:4096
    v_exp_f32 v57, v57
    v_accvgpr_read_b32 v238, a22
    v_accvgpr_read_b32 v250, a226
    v_accvgpr_read_b32 v236, a20
    v_pk_fma_f32 v[244:245], v[244:245], v[96:97], v[216:217] neg_lo:[0,0,1] neg_hi:[0,0,1]
    v_pk_fma_f32 v[232:233], v[232:233], v[96:97], v[216:217] neg_lo:[0,0,1] neg_hi:[0,0,1]
    v_exp_f32 v58, v58
    v_pk_fma_f32 v[236:237], v[236:237], v[96:97], v[216:217] neg_lo:[0,0,1] neg_hi:[0,0,1]
    v_pk_fma_f32 v[242:243], v[242:243], v[98:99], v[218:219] neg_lo:[0,0,1] neg_hi:[0,0,1]
    v_pk_fma_f32 v[240:241], v[240:241], v[96:97], v[216:217] neg_lo:[0,0,1] neg_hi:[0,0,1]
    v_cvt_pk_bf16_f32 v33, v240, v244
    v_pk_fma_f32 v[238:239], v[238:239], v[98:99], v[218:219] neg_lo:[0,0,1] neg_hi:[0,0,1]
    v_pk_fma_f32 v[234:235], v[234:235], v[98:99], v[218:219] neg_lo:[0,0,1] neg_hi:[0,0,1]
    v_pk_fma_f32 v[246:247], v[246:247], v[98:99], v[218:219] neg_lo:[0,0,1] neg_hi:[0,0,1]
    v_cvt_pk_bf16_f32 v34, v233, v237
    v_cvt_pk_bf16_f32 v32, v232, v236
    v_mfma_f32_16x16x32_bf16 a[36:39], v[84:87], a[196:199], a[36:39]
    ds_write_b64 v208, v[32:33] offset:128
    v_cvt_pk_bf16_f32 v92, v56, v57
    v_cvt_pk_bf16_f32 v36, v234, v238
    v_mfma_f32_16x16x32_bf16 a[40:43], v[84:87], a[200:203], a[40:43]
    ds_read_b128 a[128:131], v176 offset:8192
    v_cvt_pk_bf16_f32 v35, v241, v245
    v_cvt_pk_bf16_f32 v39, v243, v247
    v_mfma_f32_16x16x32_bf16 a[40:43], v[68:71], a[168:171], a[40:43]
    ds_write_b64 v209, v[34:35] offset:384
    v_cvt_pk_bf16_f32 v37, v242, v246
    v_add_f32 v251, v250, v251
    v_mfma_f32_16x16x32_bf16 v[20:23], a[156:159], v[156:159], v[104:107]
    ds_write_b64 v208, v[36:37] offset:512
    v_accvgpr_read_b32 v237, a37
    v_cvt_pk_bf16_f32 v38, v235, v239
    v_mfma_f32_16x16x32_bf16 v[20:23], a[152:155], v[152:155], v[20:23]
    ds_write_b64 v209, v[38:39] offset:768
    v_rcp_f32 v250, v251
    v_accvgpr_read_b32 v236, a36
    v_mfma_f32_16x16x32_bf16 v[28:31], a[144:147], v[160:163], v[108:111]
    ds_read_b64_tr_b16 v[32:33], v252 offset:0
    v_accvgpr_read_b32 v247, a47
    v_accvgpr_read_b32 v234, a34
    v_mfma_f32_16x16x32_bf16 v[28:31], a[148:151], v[164:167], v[28:31]
    ds_read_b64_tr_b16 v[34:35], v253 offset:0
    v_accvgpr_read_b32 v246, a46
    v_accvgpr_read_b32 v241, a41
    v_mfma_f32_16x16x32_bf16 v[28:31], a[152:155], v[168:171], v[28:31]
    ds_read_b64_tr_b16 v[36:37], v252 offset:2048
    v_accvgpr_read_b32 v233, a33
    v_accvgpr_read_b32 v243, a43
    v_mfma_f32_16x16x32_bf16 v[28:31], a[156:159], v[172:175], v[28:31]
    ds_read_b64_tr_b16 a[166:167], v181 offset:4096
    v_cvt_pk_bf16_f32 v93, v58, v59
    v_accvgpr_read_b32 v245, a45
    v_mfma_f32_16x16x4_f32 v[100:103], v250, v199, 0
    ds_read_b64_tr_b16 v[38:39], v253 offset:2048
    v_accvgpr_read_b32 v244, a44
    v_exp_f32 v61, v61
    v_exp_f32 v63, v63
    s_waitcnt lgkmcnt(3)
    v_mfma_f32_16x16x32_bf16 v[56:59], a[128:131], v[160:163], v[108:111]
    buffer_store_dwordx4 v[32:35], v248, s[16:19], 0 offen offset:128 sc1
    v_mfma_f32_16x16x32_bf16 v[56:59], a[132:135], v[164:167], v[56:59]
    ds_read_b128 a[136:139], v178 offset:8192
    v_accvgpr_read_b32 v240, a40
    v_accvgpr_read_b32 v232, a32
    v_accvgpr_read_b32 v235, a35
    v_exp_f32 v50, v50
    v_pk_mul_f32 v[222:223], v[222:223], v[102:103]
    v_mfma_f32_16x16x32_bf16 a[48:51], v[84:87], a[208:211], a[48:51]
    ds_read_b128 a[152:155], v178 offset:12288
    v_accvgpr_read_b32 v238, a38
    v_exp_f32 v48, v48
    v_mfma_f32_16x16x32_bf16 a[48:51], v[68:71], a[176:179], a[48:51]
    ds_read_b128 a[156:159], v179 offset:12288
    v_accvgpr_read_b32 v239, a39
    v_exp_f32 v60, v60
    v_accvgpr_read_b32 v242, a42
    v_pk_fma_f32 v[246:247], v[246:247], v[102:103], v[222:223] neg_lo:[0,0,1] neg_hi:[0,0,1]
    v_pk_mul_f32 v[220:221], v[220:221], v[100:101]
    v_mfma_f32_16x16x32_bf16 v[20:23], a[148:151], v[148:151], v[20:23]
    ds_read_b128 a[128:131], v176 offset:16384
    v_exp_f32 v62, v62
    v_cvt_pk_bf16_f32 v94, v60, v61
    v_exp_f32 v17, v17
    v_pk_fma_f32 v[244:245], v[244:245], v[100:101], v[220:221] neg_lo:[0,0,1] neg_hi:[0,0,1]
    v_pk_fma_f32 v[232:233], v[232:233], v[100:101], v[220:221] neg_lo:[0,0,1] neg_hi:[0,0,1]
    v_pk_fma_f32 v[240:241], v[240:241], v[100:101], v[220:221] neg_lo:[0,0,1] neg_hi:[0,0,1]
    v_pk_fma_f32 v[236:237], v[236:237], v[100:101], v[220:221] neg_lo:[0,0,1] neg_hi:[0,0,1]
    v_cvt_pk_bf16_f32 v9, v240, v244
    v_pk_fma_f32 v[238:239], v[238:239], v[102:103], v[222:223] neg_lo:[0,0,1] neg_hi:[0,0,1]
    v_cvt_pk_bf16_f32 v8, v232, v236
    v_pk_fma_f32 v[234:235], v[234:235], v[102:103], v[222:223] neg_lo:[0,0,1] neg_hi:[0,0,1]
    v_mfma_f32_16x16x32_bf16 v[20:23], a[144:147], v[144:147], v[20:23]
    s_waitcnt lgkmcnt(1)
    buffer_store_dwordx4 v[36:39], v248, s[16:19], 0 offen offset:2176 sc1
    v_mfma_f32_16x16x32_bf16 a[52:55], v[68:71], a[180:183], a[52:55]
    ds_write_b64 v208, v[8:9] offset:4096
    v_cvt_pk_bf16_f32 v14, v235, v239
    v_cvt_pk_bf16_f32 v10, v233, v237
    v_cvt_pk_bf16_f32 v11, v241, v245
    v_pk_fma_f32 v[242:243], v[242:243], v[102:103], v[222:223] neg_lo:[0,0,1] neg_hi:[0,0,1]
    v_mfma_f32_16x16x32_bf16 a[52:55], v[84:87], a[212:215], a[52:55]
    ds_read_b64_tr_b16 a[162:163], v180 offset:4096
    v_cvt_pk_bf16_f32 v13, v242, v246
    v_cvt_pk_bf16_f32 v95, v62, v63
    v_mfma_f32_16x16x32_bf16 a[56:59], v[84:87], a[216:219], a[56:59]
    ds_write_b64 v209, v[10:11] offset:4352
    v_cvt_pk_bf16_f32 v12, v234, v238
    v_cvt_pk_bf16_f32 v15, v243, v247
    v_subrev_u32 v251, 0x2b800000, v251
    v_mfma_f32_16x16x32_bf16 a[56:59], v[68:71], a[184:187], a[56:59]
    ds_write_b64 v208, v[12:13] offset:4736
    v_accvgpr_read_b32 v234, a50
    v_accvgpr_read_b32 v235, a51
    v_mfma_f32_16x16x32_bf16 a[60:63], v[68:71], a[188:191], a[60:63]
    ds_write_b64 v209, v[14:15] offset:4992
    v_accvgpr_read_b32 v236, a52
    v_exp_f32 v49, v49
    v_mfma_f32_16x16x32_bf16 a[60:63], v[84:87], a[220:223], a[60:63]
    ds_read_b64_tr_b16 v[8:9], v210 offset:4096
    ds_read_b64_tr_b16 v[10:11], v211 offset:4096
    v_mfma_f32_16x16x32_bf16 v[56:59], a[136:139], v[168:171], v[56:59]
    ds_read_b128 a[148:151], v177 offset:12288
    v_exp_f32 v51, v51
    v_exp_f32 v23, v23
    v_exp_f32 v16, v16
    v_mfma_f32_16x16x32_bf16 v[56:59], a[140:143], v[172:175], v[56:59]
    ds_read_b64_tr_b16 a[190:191], v187 offset:4096
    v_accvgpr_read_b32 v239, a55
    v_exp_f32 v18, v18
    v_mfma_f32_16x16x32_bf16 v[60:63], a[156:159], v[172:175], v[108:111]
    ds_read_b64_tr_b16 v[12:13], v210 offset:6144
    v_cvt_pk_bf16_f32 v89, v50, v51
    v_exp_f32 v52, v52
    v_mfma_f32_16x16x32_bf16 v[60:63], a[152:155], v[168:171], v[60:63]
    s_waitcnt lgkmcnt(2)
    buffer_store_dwordx4 v[8:11], v248, s[16:19], s42 offen sc1
    ds_read_b64_tr_b16 a[188:189], v187 offset:0
    v_mfma_f32_16x16x32_bf16 v[60:63], a[148:151], v[164:167], v[60:63]
    ds_read_b64_tr_b16 v[14:15], v211 offset:6144
    v_accvgpr_read_b32 v240, a56
    v_cvt_pk_bf16_f32 v90, v52, v53
    v_exp_f32 v29, v29
    v_exp_f32 v55, v55
    v_exp_f32 v54, v54
    v_accvgpr_read_b32 v244, a60
    v_exp_f32 v25, v25
    v_accvgpr_read_b32 v246, a62
    v_cvt_pk_bf16_f32 v88, v48, v49
    v_cvt_pk_bf16_f32 v91, v54, v55
    v_accvgpr_read_b32 v238, a54
    v_exp_f32 v28, v28
    v_mfma_f32_16x16x32_bf16 a[72:75], v[88:91], a[200:203], a[72:75]
    s_waitcnt lgkmcnt(0)
    buffer_store_dwordx4 v[12:15], v248, s[16:19], s42 offen offset:2048 sc1
    v_mfma_f32_16x16x32_bf16 a[64:67], v[88:91], a[192:195], a[64:67]
    ds_read_b64_tr_b16 a[170:171], v182 offset:4096
    v_exp_f32 v27, v27
    v_accvgpr_read_b32 v241, a57
    v_accvgpr_read_b32 v247, a63
    v_exp_f32 v24, v24
    v_accvgpr_read_b32 v232, a48
    v_pk_fma_f32 v[240:241], v[240:241], v[100:101], v[220:221] neg_lo:[0,0,1] neg_hi:[0,0,1]
    v_pk_fma_f32 v[238:239], v[238:239], v[102:103], v[222:223] neg_lo:[0,0,1] neg_hi:[0,0,1]
    v_pk_fma_f32 v[246:247], v[246:247], v[102:103], v[222:223] neg_lo:[0,0,1] neg_hi:[0,0,1]
    v_exp_f32 v21, v21
    v_exp_f32 v20, v20
    v_accvgpr_read_b32 v242, a58
    v_accvgpr_read_b32 v245, a61
    v_accvgpr_read_b32 v243, a59
    v_accvgpr_read_b32 v237, a53
    v_smfmac_f32_16x16x64_bf16 a[228:231], v[192:195], v[88:95], v196
    ds_read_b128 a[144:147], v176 offset:12288
    v_cvt_pk_bf16_f32 v76, v24, v25
    v_accvgpr_read_b32 v233, a49
    v_exp_f32 v19, v19
    v_pk_fma_f32 v[244:245], v[244:245], v[100:101], v[220:221] neg_lo:[0,0,1] neg_hi:[0,0,1]
    v_exp_f32 v31, v31
    v_exp_f32 v26, v26
    v_exp_f32 v30, v30
    v_pk_fma_f32 v[236:237], v[236:237], v[100:101], v[220:221] neg_lo:[0,0,1] neg_hi:[0,0,1]
    v_cvt_pk_bf16_f32 v41, v240, v244
    v_cvt_pk_bf16_f32 v74, v20, v21
    v_exp_f32 v22, v22
    v_cvt_pk_bf16_f32 v72, v16, v17
    v_cvt_pk_bf16_f32 v75, v22, v23
    v_cvt_pk_bf16_f32 v77, v26, v27
    v_cvt_pk_bf16_f32 v73, v18, v19
    v_cvt_pk_bf16_f32 v79, v30, v31
    v_pk_fma_f32 v[232:233], v[232:233], v[100:101], v[220:221] neg_lo:[0,0,1] neg_hi:[0,0,1]
    v_pk_fma_f32 v[242:243], v[242:243], v[102:103], v[222:223] neg_lo:[0,0,1] neg_hi:[0,0,1]
    v_cvt_pk_bf16_f32 v78, v28, v29
    v_pk_fma_f32 v[234:235], v[234:235], v[102:103], v[222:223] neg_lo:[0,0,1] neg_hi:[0,0,1]
    v_cvt_pk_bf16_f32 v45, v242, v246
    v_smfmac_f32_16x16x64_bf16 a[228:231], v[192:195], v[72:79], v196
    ds_read_b64_tr_b16 a[168:169], v182 offset:0
    v_cvt_pk_bf16_f32 v40, v232, v236
    v_cvt_pk_bf16_f32 v43, v241, v245
    v_mfma_f32_16x16x32_bf16 a[68:71], v[72:75], a[164:167], a[68:71]
    ds_write_b64 v208, v[40:41] offset:4224
    v_cvt_pk_bf16_f32 v42, v233, v237
    s_or_b64 s[38:39], s[38:39], vcc
    v_mfma_f32_16x16x32_bf16 a[64:67], v[72:75], a[160:163], a[64:67]
    ds_write_b64 v209, v[42:43] offset:4480
    v_cvt_pk_bf16_f32 v44, v234, v238
    v_cvt_pk_bf16_f32 v47, v243, v247
    v_mfma_f32_16x16x32_bf16 a[92:95], v[72:75], a[188:191], a[92:95]
    ds_write_b64 v208, v[44:45] offset:4608
    v_cmp_le_u32 vcc, s45, v251
    v_cvt_pk_bf16_f32 v46, v235, v239
    v_mfma_f32_16x16x32_bf16 v[24:27], a[128:131], v[160:163], v[108:111]
    ds_write_b64 v209, v[46:47] offset:4864
    v_accvgpr_read_b32 v251, a229
    s_waitcnt lgkmcnt(3)
    v_mfma_f32_16x16x32_bf16 a[72:75], v[72:75], a[168:171], a[72:75]
    ds_read_b64_tr_b16 v[40:41], v252 offset:4096
    v_accvgpr_read_b32 v250, a228
    v_mfma_f32_16x16x32_bf16 a[76:79], v[72:75], a[172:175], a[76:79]
    ds_read_b64_tr_b16 v[42:43], v253 offset:4096
    v_add_f32 v251, v250, v251
    v_mfma_f32_16x16x32_bf16 a[76:79], v[88:91], a[204:207], a[76:79]
    ds_read_b64_tr_b16 a[186:187], v186 offset:4096
    ds_read_b64_tr_b16 a[184:185], v186 offset:0
    v_mfma_f32_16x16x32_bf16 a[68:71], v[88:91], a[196:199], a[68:71]
    ds_read_b64_tr_b16 v[44:45], v252 offset:6144
    ds_read_b64_tr_b16 v[46:47], v253 offset:6144
    v_mfma_f32_16x16x32_bf16 a[80:83], v[88:91], a[208:211], a[80:83]
    ds_read_b64_tr_b16 a[176:177], v184 offset:0
    v_rcp_f32 v250, v251
    v_mfma_f32_16x16x32_bf16 v[60:63], a[144:147], v[160:163], v[60:63]
    ds_read_b64_tr_b16 a[178:179], v184 offset:4096
    v_accvgpr_read_b32 v242, a74
    v_mfma_f32_16x16x4_f32 v[104:107], v250, v199, 0
    s_waitcnt lgkmcnt(6)
    buffer_store_dwordx4 v[40:43], v248, s[16:19], s42 offen offset:128 sc1
    ds_read_b64_tr_b16 a[180:181], v185 offset:0
    v_mfma_f32_16x16x32_bf16 a[96:99], v[76:79], a[160:163], a[96:99]
    ds_read_b128 a[156:159], v179 offset:20480
    v_accvgpr_read_b32 v244, a76
    v_accvgpr_read_b32 v247, a79
    v_mfma_f32_16x16x32_bf16 a[96:99], v[92:95], a[192:195], a[96:99]
    ds_read_b128 a[144:147], v176 offset:20480
    v_accvgpr_read_b32 v246, a78
    v_accvgpr_read_b32 v240, a72
    v_mfma_f32_16x16x32_bf16 a[88:91], v[88:91], a[216:219], a[88:91]
    s_waitcnt lgkmcnt(3)
    buffer_store_dwordx4 v[44:47], v248, s[16:19], s42 offen offset:2176 sc1
    ds_read_b64_tr_b16 a[182:183], v185 offset:4096
    v_mfma_f32_16x16x32_bf16 a[88:91], v[72:75], a[184:187], a[88:91]
    ds_read_b128 a[140:143], v179 offset:16384
    v_accvgpr_read_b32 v235, a67
    v_accvgpr_read_b32 v237, a69
    v_mfma_f32_16x16x32_bf16 a[80:83], v[72:75], a[176:179], a[80:83]
    ds_read_b128 a[132:135], v177 offset:16384
    v_accvgpr_read_b32 v233, a65
    v_accvgpr_read_b32 v241, a73
    v_accvgpr_read_b32 v232, a64
    v_accvgpr_read_b32 v239, a71
    v_pk_mul_f32 v[224:225], v[224:225], v[104:105]
    v_pk_mul_f32 v[226:227], v[226:227], v[106:107]
    v_pk_fma_f32 v[246:247], v[246:247], v[106:107], v[226:227] neg_lo:[0,0,1] neg_hi:[0,0,1]
    v_accvgpr_read_b32 v236, a68
    v_pk_fma_f32 v[236:237], v[236:237], v[104:105], v[224:225] neg_lo:[0,0,1] neg_hi:[0,0,1]
    v_accvgpr_read_b32 v245, a77
    v_pk_fma_f32 v[240:241], v[240:241], v[104:105], v[224:225] neg_lo:[0,0,1] neg_hi:[0,0,1]
    v_accvgpr_read_b32 v243, a75
    v_accvgpr_read_b32 v238, a70
    v_pk_fma_f32 v[242:243], v[242:243], v[106:107], v[226:227] neg_lo:[0,0,1] neg_hi:[0,0,1]
    v_cvt_pk_bf16_f32 v21, v242, v246
    v_pk_fma_f32 v[232:233], v[232:233], v[104:105], v[224:225] neg_lo:[0,0,1] neg_hi:[0,0,1]
    v_pk_fma_f32 v[244:245], v[244:245], v[104:105], v[224:225] neg_lo:[0,0,1] neg_hi:[0,0,1]
    v_pk_fma_f32 v[238:239], v[238:239], v[106:107], v[226:227] neg_lo:[0,0,1] neg_hi:[0,0,1]
    v_accvgpr_read_b32 v234, a66
    v_pk_fma_f32 v[234:235], v[234:235], v[106:107], v[226:227] neg_lo:[0,0,1] neg_hi:[0,0,1]
    s_waitcnt lgkmcnt(0)
    v_mfma_f32_16x16x32_bf16 a[84:87], v[72:75], a[180:183], a[84:87]
    ds_read_b128 a[136:139], v178 offset:16384
    v_cvt_pk_bf16_f32 v16, v232, v236
    v_cvt_pk_bf16_f32 v17, v240, v244
    v_mfma_f32_16x16x32_bf16 a[84:87], v[88:91], a[212:215], a[84:87]
    ds_read_b64_tr_b16 a[192:193], v180 offset:8192
    v_cvt_pk_bf16_f32 v23, v243, v247
    v_cvt_pk_bf16_f32 v20, v234, v238
    v_mfma_f32_16x16x32_bf16 a[92:95], v[88:91], a[220:223], a[92:95]
    ds_write_b64 v208, v[16:17] offset:0
    v_cvt_pk_bf16_f32 v19, v241, v245
    v_cvt_pk_bf16_f32 v18, v233, v237
    v_mfma_f32_16x16x32_bf16 a[104:107], v[76:79], a[168:171], a[104:107]
    ds_read_b128 a[152:155], v178 offset:20480
    v_accvgpr_read_b32 v234, a82
    v_mfma_f32_16x16x32_bf16 a[120:123], v[76:79], a[184:187], a[120:123]
    ds_write_b64 v209, v[18:19] offset:256
    v_accvgpr_read_b32 v233, a81
    v_mfma_f32_16x16x32_bf16 a[120:123], v[92:95], a[216:219], a[120:123]
    ds_write_b64 v208, v[20:21] offset:640
    v_accvgpr_read_b32 v246, a94
    v_accvgpr_read_b32 v244, a92
    v_cvt_pk_bf16_f32 v22, v235, v239
    v_mfma_f32_16x16x32_bf16 a[104:107], v[92:95], a[200:203], a[104:107]
    ds_write_b64 v209, v[22:23] offset:896
    v_accvgpr_read_b32 v240, a88
    s_or_b64 s[38:39], s[38:39], vcc
    v_mfma_f32_16x16x32_bf16 v[24:27], a[132:135], v[164:167], v[24:27]
    ds_read_b64_tr_b16 v[16:17], v210 offset:0
    v_accvgpr_read_b32 v236, a84
    s_waitcnt lgkmcnt(3)
    v_mfma_f32_16x16x32_bf16 v[24:27], a[136:139], v[168:171], v[24:27]
    ds_read_b64_tr_b16 v[18:19], v211 offset:0
    ds_read_b64_tr_b16 a[194:195], v180 offset:12288
    v_mfma_f32_16x16x32_bf16 v[24:27], a[140:143], v[172:175], v[24:27]
    ds_read_b64_tr_b16 a[128:129], v180 offset:16384
    ds_read_b64_tr_b16 v[20:21], v210 offset:2048
    v_mfma_f32_16x16x32_bf16 a[112:115], v[76:79], a[176:179], a[112:115]
    ds_read_b64_tr_b16 a[140:141], v183 offset:16384
    ds_read_b64_tr_b16 v[22:23], v211 offset:2048
    v_mfma_f32_16x16x32_bf16 a[112:115], v[92:95], a[208:211], a[112:115]
    ds_read_b128 a[148:151], v177 offset:20480
    v_accvgpr_read_b32 v239, a87
    v_accvgpr_read_b32 v235, a83
    v_exp_f32 v24, v24
    v_accvgpr_read_b32 v247, a95
    v_accvgpr_read_b32 v245, a93
    v_mfma_f32_16x16x32_bf16 a[108:111], v[92:95], a[204:207], a[108:111]
    s_waitcnt lgkmcnt(6)
    buffer_store_dwordx4 v[16:19], v248, s[16:19], s43 offen sc1
    ds_read_b64_tr_b16 a[206:207], v183 offset:12288
    v_mfma_f32_16x16x32_bf16 v[28:31], a[156:159], v[172:175], v[108:111]
    ds_read_b64_tr_b16 a[200:201], v182 offset:8192
    v_exp_f32 v57, v57
    v_accvgpr_read_b32 v237, a85
    v_mfma_f32_16x16x32_bf16 v[28:31], a[152:155], v[168:171], v[28:31]
    s_waitcnt lgkmcnt(2)
    buffer_store_dwordx4 v[20:23], v248, s[16:19], s43 offen offset:2048 sc1
    ds_read_b64_tr_b16 a[132:133], v181 offset:16384
    v_mfma_f32_16x16x32_bf16 v[28:31], a[148:151], v[164:167], v[28:31]
    ds_read_b64_tr_b16 a[134:135], v181 offset:20480
    ds_read_b64_tr_b16 a[130:131], v180 offset:20480
    v_mfma_f32_16x16x32_bf16 v[28:31], a[144:147], v[160:163], v[28:31]
    ds_read_b64_tr_b16 a[154:155], v186 offset:20480
    v_accvgpr_read_b32 v243, a91
    v_accvgpr_read_b32 v232, a80
    v_exp_f32 v62, v62
    v_exp_f32 v60, v60
    v_pk_fma_f32 v[244:245], v[244:245], v[104:105], v[224:225] neg_lo:[0,0,1] neg_hi:[0,0,1]
    v_pk_fma_f32 v[232:233], v[232:233], v[104:105], v[224:225] neg_lo:[0,0,1] neg_hi:[0,0,1]
    v_accvgpr_read_b32 v241, a89
    v_accvgpr_read_b32 v242, a90
    v_pk_fma_f32 v[242:243], v[242:243], v[106:107], v[226:227] neg_lo:[0,0,1] neg_hi:[0,0,1]
    v_pk_fma_f32 v[236:237], v[236:237], v[104:105], v[224:225] neg_lo:[0,0,1] neg_hi:[0,0,1]
    v_accvgpr_read_b32 v238, a86
    v_exp_f32 v63, v63
    v_pk_fma_f32 v[240:241], v[240:241], v[104:105], v[224:225] neg_lo:[0,0,1] neg_hi:[0,0,1]
    v_cvt_pk_bf16_f32 v50, v233, v237
    v_cvt_pk_bf16_f32 v49, v240, v244
    v_pk_fma_f32 v[238:239], v[238:239], v[106:107], v[226:227] neg_lo:[0,0,1] neg_hi:[0,0,1]
    v_cvt_pk_bf16_f32 v48, v232, v236
    v_exp_f32 v56, v56
    v_exp_f32 v25, v25
    v_pk_fma_f32 v[234:235], v[234:235], v[106:107], v[226:227] neg_lo:[0,0,1] neg_hi:[0,0,1]
    v_mfma_f32_16x16x32_bf16 a[124:127], v[92:95], a[220:223], a[124:127]
    ds_write_b64 v208, v[48:49] offset:128
    v_exp_f32 v28, v28
    v_cvt_pk_bf16_f32 v52, v234, v238
    v_cvt_pk_bf16_f32 v54, v235, v239
    v_pk_fma_f32 v[246:247], v[246:247], v[106:107], v[226:227] neg_lo:[0,0,1] neg_hi:[0,0,1]
    v_exp_f32 v29, v29
    v_cvt_pk_bf16_f32 v53, v242, v246
    v_exp_f32 v59, v59
    v_cvt_pk_bf16_f32 v51, v241, v245
    v_mfma_f32_16x16x32_bf16 a[100:103], v[92:95], a[196:199], a[100:103]
    ds_write_b64 v209, v[50:51] offset:384
    v_cvt_pk_bf16_f32 v55, v243, v247
    v_subrev_u32 v251, 0x2b800000, v251
    v_mfma_f32_16x16x32_bf16 a[116:119], v[92:95], a[212:215], a[116:119]
    ds_write_b64 v208, v[52:53] offset:512
    v_exp_f32 v61, v61
    v_exp_f32 v27, v27
    v_mfma_f32_16x16x32_bf16 a[116:119], v[76:79], a[180:183], a[116:119]
    ds_write_b64 v209, v[54:55] offset:768
    v_exp_f32 v26, v26
    v_mfma_f32_16x16x32_bf16 a[124:127], v[76:79], a[188:191], a[124:127]
    ds_read_b64_tr_b16 v[48:49], v252 offset:0
    ds_read_b64_tr_b16 a[204:205], v183 offset:8192
    v_mfma_f32_16x16x32_bf16 a[100:103], v[76:79], a[164:167], a[100:103]
    ds_read_b64_tr_b16 v[50:51], v253 offset:0
    ds_read_b64_tr_b16 a[142:143], v183 offset:20480
    v_mfma_f32_16x16x32_bf16 a[108:111], v[76:79], a[172:175], a[108:111]
    ds_read_b64_tr_b16 a[198:199], v181 offset:12288
    v_exp_f32 v58, v58
    v_cvt_pk_bf16_f32 v92, v56, v57
    v_cvt_pk_bf16_f32 v76, v24, v25
    v_exp_f32 v31, v31
    v_cvt_pk_bf16_f32 v78, v28, v29
    v_cvt_pk_bf16_f32 v95, v62, v63
    v_exp_f32 v30, v30
    v_cvt_pk_bf16_f32 v94, v60, v61
    v_cvt_pk_bf16_f32 v93, v58, v59
    v_cvt_pk_bf16_f32 v77, v26, v27
    v_cvt_pk_bf16_f32 v79, v30, v31
    v_cmp_le_u32 vcc, s45, v251
    v_smfmac_f32_16x16x64_bf16 a[228:231], v[192:195], v[88:95], v196
    s_waitcnt lgkmcnt(1)
    buffer_store_dwordx4 v[48:51], v248, s[16:19], s43 offen offset:128 sc1
    ds_read_b64_tr_b16 a[202:203], v182 offset:12288
    v_smfmac_f32_16x16x64_bf16 a[228:231], v[192:195], v[72:79], v196
    ds_read_b64_tr_b16 a[136:137], v182 offset:16384
    ds_read_b64_tr_b16 a[138:139], v182 offset:20480
    v_mfma_f32_16x16x32_bf16 a[96:99], v[92:95], a[192:195], a[96:99]
    ds_read_b64_tr_b16 a[218:219], v186 offset:12288
    ds_read_b64_tr_b16 v[52:53], v252 offset:2048
    v_mfma_f32_16x16x32_bf16 a[96:99], v[76:79], a[128:131], a[96:99]
    ds_read_b64_tr_b16 v[54:55], v253 offset:2048
    ds_read_b64_tr_b16 a[196:197], v181 offset:8192
    v_mfma_f32_16x16x32_bf16 a[108:111], v[76:79], a[140:143], a[108:111]
    ds_read_b64_tr_b16 a[156:157], v187 offset:16384
    ds_read_b64_tr_b16 a[220:221], v187 offset:8192
    v_mfma_f32_16x16x32_bf16 a[108:111], v[92:95], a[204:207], a[108:111]
    ds_read_b64_tr_b16 a[148:149], v185 offset:16384
    v_accvgpr_read_b32 v250, a230
    v_accvgpr_read_b32 v232, a96
    s_waitcnt lgkmcnt(9)
    v_mfma_f32_16x16x32_bf16 a[104:107], v[92:95], a[200:203], a[104:107]
    ds_read_b64_tr_b16 a[152:153], v186 offset:16384
    v_accvgpr_read_b32 v251, a231
    v_add_f32 v251, v250, v251
    s_waitcnt lgkmcnt(7)
    v_mfma_f32_16x16x32_bf16 a[104:107], v[76:79], a[136:139], a[104:107]
    ds_read_b64_tr_b16 a[222:223], v187 offset:12288
    v_rcp_f32 v250, v251
    v_mfma_f32_16x16x32_bf16 a[100:103], v[76:79], a[132:135], a[100:103]
    ds_read_b64_tr_b16 a[216:217], v186 offset:8192
    s_waitcnt lgkmcnt(5)
    v_mfma_f32_16x16x32_bf16 a[100:103], v[92:95], a[196:199], a[100:103]
    buffer_store_dwordx4 v[52:55], v248, s[16:19], s43 offen offset:2176 sc1
    v_mfma_f32_16x16x4_f32 v[108:111], v250, v199, 0
    ds_read_b64_tr_b16 a[158:159], v187 offset:20480
    v_accvgpr_read_b32 v241, a105
    v_accvgpr_read_b32 v234, a98
    v_accvgpr_read_b32 v245, a109
    v_accvgpr_read_b32 v240, a104
    v_accvgpr_read_b32 v243, a107
    v_accvgpr_read_b32 v242, a106
    v_accvgpr_read_b32 v233, a97
    v_accvgpr_read_b32 v235, a99
    v_accvgpr_read_b32 v246, a110
    v_accvgpr_read_b32 v247, a111
    v_accvgpr_read_b32 v244, a108
    v_pk_mul_f32 v[230:231], v[230:231], v[110:111]
    v_pk_mul_f32 v[228:229], v[228:229], v[108:109]
    v_pk_fma_f32 v[244:245], v[244:245], v[108:109], v[228:229] neg_lo:[0,0,1] neg_hi:[0,0,1]
    v_pk_fma_f32 v[232:233], v[232:233], v[108:109], v[228:229] neg_lo:[0,0,1] neg_hi:[0,0,1]
    v_accvgpr_read_b32 v236, a100
    v_pk_fma_f32 v[246:247], v[246:247], v[110:111], v[230:231] neg_lo:[0,0,1] neg_hi:[0,0,1]
    v_accvgpr_read_b32 v237, a101
    v_accvgpr_read_b32 v238, a102
    v_pk_fma_f32 v[240:241], v[240:241], v[108:109], v[228:229] neg_lo:[0,0,1] neg_hi:[0,0,1]
    v_accvgpr_read_b32 v239, a103
    v_pk_fma_f32 v[236:237], v[236:237], v[108:109], v[228:229] neg_lo:[0,0,1] neg_hi:[0,0,1]
    v_cvt_pk_bf16_f32 v24, v232, v236
    v_cvt_pk_bf16_f32 v25, v240, v244
    ds_write_b64 v208, v[24:25] offset:4096
    v_cvt_pk_bf16_f32 v26, v233, v237
    v_pk_fma_f32 v[234:235], v[234:235], v[110:111], v[230:231] neg_lo:[0,0,1] neg_hi:[0,0,1]
    v_pk_fma_f32 v[238:239], v[238:239], v[110:111], v[230:231] neg_lo:[0,0,1] neg_hi:[0,0,1]
    v_pk_fma_f32 v[242:243], v[242:243], v[110:111], v[230:231] neg_lo:[0,0,1] neg_hi:[0,0,1]
    v_cvt_pk_bf16_f32 v29, v242, v246
    v_cvt_pk_bf16_f32 v27, v241, v245
    ds_write_b64 v209, v[26:27] offset:4352
    v_cvt_pk_bf16_f32 v28, v234, v238
    s_waitcnt lgkmcnt(2)
    v_mfma_f32_16x16x32_bf16 a[124:127], v[76:79], a[156:159], a[124:127]
    ds_write_b64 v208, v[28:29] offset:4736
    v_cvt_pk_bf16_f32 v31, v243, v247
    v_cvt_pk_bf16_f32 v30, v235, v239
    ds_write_b64 v209, v[30:31] offset:4992
    ds_read_b64_tr_b16 v[24:25], v210 offset:4096
    ds_read_b64_tr_b16 v[26:27], v211 offset:4096
    ds_read_b64_tr_b16 a[150:151], v185 offset:20480
    v_mfma_f32_16x16x32_bf16 a[124:127], v[92:95], a[220:223], a[124:127]
    ds_read_b64_tr_b16 v[28:29], v210 offset:6144
    ds_read_b64_tr_b16 v[30:31], v211 offset:6144
    ds_read_b64_tr_b16 a[146:147], v184 offset:20480
    ds_read_b64_tr_b16 a[212:213], v185 offset:8192
    v_mfma_f32_16x16x32_bf16 a[120:123], v[92:95], a[216:219], a[120:123]
    ds_read_b64_tr_b16 a[214:215], v185 offset:12288
    ds_read_b64_tr_b16 a[208:209], v184 offset:8192
    ds_read_b64_tr_b16 a[210:211], v184 offset:12288
    ds_read_b64_tr_b16 a[144:145], v184 offset:16384
    v_mfma_f32_16x16x32_bf16 a[120:123], v[76:79], a[152:155], a[120:123]
    s_waitcnt lgkmcnt(9)
    buffer_store_dwordx4 v[24:27], v248, s[16:19], s44 offen sc1
    s_waitcnt lgkmcnt(6)
    v_mfma_f32_16x16x32_bf16 a[116:119], v[76:79], a[148:151], a[116:119]
    buffer_store_dwordx4 v[28:31], v248, s[16:19], s44 offen offset:2048 sc1
    s_waitcnt lgkmcnt(3)
    v_mfma_f32_16x16x32_bf16 a[116:119], v[92:95], a[212:215], a[116:119]
    v_accvgpr_read_b32 v247, a127
    v_accvgpr_read_b32 v245, a125
    s_waitcnt lgkmcnt(0)
    v_mfma_f32_16x16x32_bf16 a[112:115], v[92:95], a[208:211], a[112:115]
    v_accvgpr_read_b32 v244, a124
    v_accvgpr_read_b32 v243, a123
    v_mfma_f32_16x16x32_bf16 a[112:115], v[76:79], a[144:147], a[112:115]
    v_accvgpr_read_b32 v246, a126
    v_accvgpr_read_b32 v237, a117
    v_accvgpr_read_b32 v238, a118
    v_accvgpr_read_b32 v241, a121
    v_accvgpr_read_b32 v236, a116
    v_accvgpr_read_b32 v240, a120
    v_pk_fma_f32 v[244:245], v[244:245], v[108:109], v[228:229] neg_lo:[0,0,1] neg_hi:[0,0,1]
    v_subrev_u32 v251, 0x2b800000, v251
    v_accvgpr_read_b32 v242, a122
    v_accvgpr_read_b32 v239, a119
    v_accvgpr_read_b32 v235, a115
    v_pk_fma_f32 v[246:247], v[246:247], v[110:111], v[230:231] neg_lo:[0,0,1] neg_hi:[0,0,1]
    v_accvgpr_read_b32 v232, a112
    v_accvgpr_read_b32 v234, a114
    v_pk_fma_f32 v[236:237], v[236:237], v[108:109], v[228:229] neg_lo:[0,0,1] neg_hi:[0,0,1]
    v_accvgpr_read_b32 v233, a113
    v_pk_fma_f32 v[240:241], v[240:241], v[108:109], v[228:229] neg_lo:[0,0,1] neg_hi:[0,0,1]
    v_pk_fma_f32 v[232:233], v[232:233], v[108:109], v[228:229] neg_lo:[0,0,1] neg_hi:[0,0,1]
    v_pk_fma_f32 v[238:239], v[238:239], v[110:111], v[230:231] neg_lo:[0,0,1] neg_hi:[0,0,1]
    v_pk_fma_f32 v[242:243], v[242:243], v[110:111], v[230:231] neg_lo:[0,0,1] neg_hi:[0,0,1]
    v_cvt_pk_bf16_f32 v56, v232, v236
    v_cvt_pk_bf16_f32 v61, v242, v246
    v_pk_fma_f32 v[234:235], v[234:235], v[110:111], v[230:231] neg_lo:[0,0,1] neg_hi:[0,0,1]
    v_cvt_pk_bf16_f32 v57, v240, v244
    ds_write_b64 v208, v[56:57] offset:4224
    v_cvt_pk_bf16_f32 v59, v241, v245
    v_cvt_pk_bf16_f32 v58, v233, v237
    ds_write_b64 v209, v[58:59] offset:4480
    v_cvt_pk_bf16_f32 v60, v234, v238
    ds_write_b64 v208, v[60:61] offset:4608
    v_cvt_pk_bf16_f32 v62, v235, v239
    v_cvt_pk_bf16_f32 v63, v243, v247
    ds_write_b64 v209, v[62:63] offset:4864
    s_or_b64 s[38:39], s[38:39], vcc
    ds_read_b64_tr_b16 v[56:57], v252 offset:4096
    ds_read_b64_tr_b16 v[58:59], v253 offset:4096
    ds_read_b64_tr_b16 v[60:61], v252 offset:6144
    v_cmp_le_u32 vcc, s45, v251
    s_nop 0
    s_or_b64 s[38:39], s[38:39], vcc
    ds_read_b64_tr_b16 v[62:63], v253 offset:6144
    s_waitcnt lgkmcnt(2)
    buffer_store_dwordx4 v[56:59], v248, s[16:19], s44 offen offset:128 sc1
    s_waitcnt lgkmcnt(0)
    buffer_store_dwordx4 v[60:63], v248, s[16:19], s44 offen offset:2176 sc1
    s_cmp_lg_u64 s[38:39], 0
    s_cbranch_scc1 L_fb
L_end:
    s_endpgm
L_fb:
    s_waitcnt vmcnt(0) lgkmcnt(0)
    v_and_b32 v1, 15, v197
    v_lshrrev_b32 v2, 4, v197
    s_sub_u32 s46, s23, 65536
    s_add_u32 s47, s23, 4096
    v_xor_b32 v4, 0, v2
    v_xor_b32 v5, v4, v1
    v_lshlrev_b32 v5, 4, v5
    v_lshl_add_u32 v232, v2, 8, v5
    v_xor_b32 v4, 8, v2
    v_xor_b32 v5, v4, v1
    v_lshlrev_b32 v5, 4, v5
    v_lshl_add_u32 v233, v2, 8, v5
    v_add_u32 v180, s46, v180
    v_add_u32 v181, s46, v181
    v_add_u32 v182, s46, v182
    v_add_u32 v183, s46, v183
    v_add_u32 v184, s46, v184
    v_add_u32 v185, s46, v185
    v_add_u32 v186, s46, v186
    v_add_u32 v187, s46, v187
    v_mov_b32 v234, 0xff800000
    v_mov_b32 v235, 0xff800000
    v_mov_b32 v236, 0xff800000
    v_mov_b32 v237, 0xff800000
    s_mov_b32 s24, 0
L_fb1:
    s_mov_b32 m0, s23
    s_add_u32 s48, s24, 0
    buffer_load_dwordx4 v200, s[4:7], s48 offen lds
    buffer_load_dwordx4 v201, s[4:7], s48 offen offset:1024 lds
    buffer_load_dwordx4 v202, s[4:7], s48 offen offset:2048 lds
    buffer_load_dwordx4 v203, s[4:7], s48 offen offset:3072 lds
    s_mov_b32 m0, s47
    s_add_u32 s48, s24, 4096
    buffer_load_dwordx4 v200, s[4:7], s48 offen lds
    buffer_load_dwordx4 v201, s[4:7], s48 offen offset:1024 lds
    buffer_load_dwordx4 v202, s[4:7], s48 offen offset:2048 lds
    buffer_load_dwordx4 v203, s[4:7], s48 offen offset:3072 lds
    s_waitcnt vmcnt(0)
    ds_read_b128 a[128:131], v204 offset:32768
    ds_read_b128 a[132:135], v205 offset:32768
    ds_read_b128 a[136:139], v206 offset:32768
    ds_read_b128 a[140:143], v207 offset:32768
    ds_read_b128 a[144:147], v204 offset:36864
    ds_read_b128 a[148:151], v205 offset:36864
    ds_read_b128 a[152:155], v206 offset:36864
    ds_read_b128 a[156:159], v207 offset:36864
    s_waitcnt lgkmcnt(0)
    v_mfma_f32_16x16x32_bf16 v[0:3], a[128:131], v[112:115], 0
    v_mfma_f32_16x16x32_bf16 v[0:3], a[132:135], v[116:119], v[0:3]
    v_mfma_f32_16x16x32_bf16 v[0:3], a[136:139], v[120:123], v[0:3]
    v_mfma_f32_16x16x32_bf16 v[0:3], a[140:143], v[124:127], v[0:3]
    v_mfma_f32_16x16x32_bf16 v[4:7], a[144:147], v[112:115], 0
    v_mfma_f32_16x16x32_bf16 v[4:7], a[148:151], v[116:119], v[4:7]
    v_mfma_f32_16x16x32_bf16 v[4:7], a[152:155], v[120:123], v[4:7]
    v_mfma_f32_16x16x32_bf16 v[4:7], a[156:159], v[124:127], v[4:7]
    v_mfma_f32_16x16x32_bf16 v[8:11], a[128:131], v[128:131], 0
    v_mfma_f32_16x16x32_bf16 v[8:11], a[132:135], v[132:135], v[8:11]
    v_mfma_f32_16x16x32_bf16 v[8:11], a[136:139], v[136:139], v[8:11]
    v_mfma_f32_16x16x32_bf16 v[8:11], a[140:143], v[140:143], v[8:11]
    v_mfma_f32_16x16x32_bf16 v[12:15], a[144:147], v[128:131], 0
    v_mfma_f32_16x16x32_bf16 v[12:15], a[148:151], v[132:135], v[12:15]
    v_mfma_f32_16x16x32_bf16 v[12:15], a[152:155], v[136:139], v[12:15]
    v_mfma_f32_16x16x32_bf16 v[12:15], a[156:159], v[140:143], v[12:15]
    v_mfma_f32_16x16x32_bf16 v[16:19], a[128:131], v[144:147], 0
    v_mfma_f32_16x16x32_bf16 v[16:19], a[132:135], v[148:151], v[16:19]
    v_mfma_f32_16x16x32_bf16 v[16:19], a[136:139], v[152:155], v[16:19]
    v_mfma_f32_16x16x32_bf16 v[16:19], a[140:143], v[156:159], v[16:19]
    v_mfma_f32_16x16x32_bf16 v[20:23], a[144:147], v[144:147], 0
    v_mfma_f32_16x16x32_bf16 v[20:23], a[148:151], v[148:151], v[20:23]
    v_mfma_f32_16x16x32_bf16 v[20:23], a[152:155], v[152:155], v[20:23]
    v_mfma_f32_16x16x32_bf16 v[20:23], a[156:159], v[156:159], v[20:23]
    v_mfma_f32_16x16x32_bf16 v[24:27], a[128:131], v[160:163], 0
    v_mfma_f32_16x16x32_bf16 v[24:27], a[132:135], v[164:167], v[24:27]
    v_mfma_f32_16x16x32_bf16 v[24:27], a[136:139], v[168:171], v[24:27]
    v_mfma_f32_16x16x32_bf16 v[24:27], a[140:143], v[172:175], v[24:27]
    v_mfma_f32_16x16x32_bf16 v[28:31], a[144:147], v[160:163], 0
    v_mfma_f32_16x16x32_bf16 v[28:31], a[148:151], v[164:167], v[28:31]
    v_mfma_f32_16x16x32_bf16 v[28:31], a[152:155], v[168:171], v[28:31]
    v_mfma_f32_16x16x32_bf16 v[28:31], a[156:159], v[172:175], v[28:31]
    s_nop 15
    v_max3_f32 v234, v234, v0, v1
    v_max3_f32 v234, v234, v2, v3
    v_max3_f32 v234, v234, v4, v5
    v_max3_f32 v234, v234, v6, v7
    v_max3_f32 v235, v235, v8, v9
    v_max3_f32 v235, v235, v10, v11
    v_max3_f32 v235, v235, v12, v13
    v_max3_f32 v235, v235, v14, v15
    v_max3_f32 v236, v236, v16, v17
    v_max3_f32 v236, v236, v18, v19
    v_max3_f32 v236, v236, v20, v21
    v_max3_f32 v236, v236, v22, v23
    v_max3_f32 v237, v237, v24, v25
    v_max3_f32 v237, v237, v26, v27
    v_max3_f32 v237, v237, v28, v29
    v_max3_f32 v237, v237, v30, v31
    s_add_u32 s24, s24, 8192
    s_cmp_lt_u32 s24, 0x80000
    s_cbranch_scc1 L_fb1
    v_mov_b32 v238, v234
    s_nop 1
    v_permlane32_swap_b32 v234, v238
    s_nop 0
    v_max_f32 v234, v234, v238
    v_mov_b32 v238, v234
    s_nop 1
    v_permlane16_swap_b32 v234, v238
    s_nop 0
    v_max_f32 v234, v234, v238
    v_sub_f32 v96, 0, v234
    v_sub_f32 v97, 0, v234
    v_sub_f32 v98, 0, v234
    v_sub_f32 v99, 0, v234
    v_mov_b32 v238, v235
    s_nop 1
    v_permlane32_swap_b32 v235, v238
    s_nop 0
    v_max_f32 v235, v235, v238
    v_mov_b32 v238, v235
    s_nop 1
    v_permlane16_swap_b32 v235, v238
    s_nop 0
    v_max_f32 v235, v235, v238
    v_sub_f32 v100, 0, v235
    v_sub_f32 v101, 0, v235
    v_sub_f32 v102, 0, v235
    v_sub_f32 v103, 0, v235
    v_mov_b32 v238, v236
    s_nop 1
    v_permlane32_swap_b32 v236, v238
    s_nop 0
    v_max_f32 v236, v236, v238
    v_mov_b32 v238, v236
    s_nop 1
    v_permlane16_swap_b32 v236, v238
    s_nop 0
    v_max_f32 v236, v236, v238
    v_sub_f32 v104, 0, v236
    v_sub_f32 v105, 0, v236
    v_sub_f32 v106, 0, v236
    v_sub_f32 v107, 0, v236
    v_mov_b32 v238, v237
    s_nop 1
    v_permlane32_swap_b32 v237, v238
    s_nop 0
    v_max_f32 v237, v237, v238
    v_mov_b32 v238, v237
    s_nop 1
    v_permlane16_swap_b32 v237, v238
    s_nop 0
    v_max_f32 v237, v237, v238
    v_sub_f32 v108, 0, v237
    v_sub_f32 v109, 0, v237
    v_sub_f32 v110, 0, v237
    v_sub_f32 v111, 0, v237
    v_accvgpr_write_b32 a0, 0
    v_accvgpr_write_b32 a1, 0
    v_accvgpr_write_b32 a2, 0
    v_accvgpr_write_b32 a3, 0
    v_accvgpr_write_b32 a4, 0
    v_accvgpr_write_b32 a5, 0
    v_accvgpr_write_b32 a6, 0
    v_accvgpr_write_b32 a7, 0
    v_accvgpr_write_b32 a8, 0
    v_accvgpr_write_b32 a9, 0
    v_accvgpr_write_b32 a10, 0
    v_accvgpr_write_b32 a11, 0
    v_accvgpr_write_b32 a12, 0
    v_accvgpr_write_b32 a13, 0
    v_accvgpr_write_b32 a14, 0
    v_accvgpr_write_b32 a15, 0
    v_accvgpr_write_b32 a16, 0
    v_accvgpr_write_b32 a17, 0
    v_accvgpr_write_b32 a18, 0
    v_accvgpr_write_b32 a19, 0
    v_accvgpr_write_b32 a20, 0
    v_accvgpr_write_b32 a21, 0
    v_accvgpr_write_b32 a22, 0
    v_accvgpr_write_b32 a23, 0
    v_accvgpr_write_b32 a24, 0
    v_accvgpr_write_b32 a25, 0
    v_accvgpr_write_b32 a26, 0
    v_accvgpr_write_b32 a27, 0
    v_accvgpr_write_b32 a28, 0
    v_accvgpr_write_b32 a29, 0
    v_accvgpr_write_b32 a30, 0
    v_accvgpr_write_b32 a31, 0
    v_accvgpr_write_b32 a32, 0
    v_accvgpr_write_b32 a33, 0
    v_accvgpr_write_b32 a34, 0
    v_accvgpr_write_b32 a35, 0
    v_accvgpr_write_b32 a36, 0
    v_accvgpr_write_b32 a37, 0
    v_accvgpr_write_b32 a38, 0
    v_accvgpr_write_b32 a39, 0
    v_accvgpr_write_b32 a40, 0
    v_accvgpr_write_b32 a41, 0
    v_accvgpr_write_b32 a42, 0
    v_accvgpr_write_b32 a43, 0
    v_accvgpr_write_b32 a44, 0
    v_accvgpr_write_b32 a45, 0
    v_accvgpr_write_b32 a46, 0
    v_accvgpr_write_b32 a47, 0
    v_accvgpr_write_b32 a48, 0
    v_accvgpr_write_b32 a49, 0
    v_accvgpr_write_b32 a50, 0
    v_accvgpr_write_b32 a51, 0
    v_accvgpr_write_b32 a52, 0
    v_accvgpr_write_b32 a53, 0
    v_accvgpr_write_b32 a54, 0
    v_accvgpr_write_b32 a55, 0
    v_accvgpr_write_b32 a56, 0
    v_accvgpr_write_b32 a57, 0
    v_accvgpr_write_b32 a58, 0
    v_accvgpr_write_b32 a59, 0
    v_accvgpr_write_b32 a60, 0
    v_accvgpr_write_b32 a61, 0
    v_accvgpr_write_b32 a62, 0
    v_accvgpr_write_b32 a63, 0
    v_accvgpr_write_b32 a64, 0
    v_accvgpr_write_b32 a65, 0
    v_accvgpr_write_b32 a66, 0
    v_accvgpr_write_b32 a67, 0
    v_accvgpr_write_b32 a68, 0
    v_accvgpr_write_b32 a69, 0
    v_accvgpr_write_b32 a70, 0
    v_accvgpr_write_b32 a71, 0
    v_accvgpr_write_b32 a72, 0
    v_accvgpr_write_b32 a73, 0
    v_accvgpr_write_b32 a74, 0
    v_accvgpr_write_b32 a75, 0
    v_accvgpr_write_b32 a76, 0
    v_accvgpr_write_b32 a77, 0
    v_accvgpr_write_b32 a78, 0
    v_accvgpr_write_b32 a79, 0
    v_accvgpr_write_b32 a80, 0
    v_accvgpr_write_b32 a81, 0
    v_accvgpr_write_b32 a82, 0
    v_accvgpr_write_b32 a83, 0
    v_accvgpr_write_b32 a84, 0
    v_accvgpr_write_b32 a85, 0
    v_accvgpr_write_b32 a86, 0
    v_accvgpr_write_b32 a87, 0
    v_accvgpr_write_b32 a88, 0
    v_accvgpr_write_b32 a89, 0
    v_accvgpr_write_b32 a90, 0
    v_accvgpr_write_b32 a91, 0
    v_accvgpr_write_b32 a92, 0
    v_accvgpr_write_b32 a93, 0
    v_accvgpr_write_b32 a94, 0
    v_accvgpr_write_b32 a95, 0
    v_accvgpr_write_b32 a96, 0
    v_accvgpr_write_b32 a97, 0
    v_accvgpr_write_b32 a98, 0
    v_accvgpr_write_b32 a99, 0
    v_accvgpr_write_b32 a100, 0
    v_accvgpr_write_b32 a101, 0
    v_accvgpr_write_b32 a102, 0
    v_accvgpr_write_b32 a103, 0
    v_accvgpr_write_b32 a104, 0
    v_accvgpr_write_b32 a105, 0
    v_accvgpr_write_b32 a106, 0
    v_accvgpr_write_b32 a107, 0
    v_accvgpr_write_b32 a108, 0
    v_accvgpr_write_b32 a109, 0
    v_accvgpr_write_b32 a110, 0
    v_accvgpr_write_b32 a111, 0
    v_accvgpr_write_b32 a112, 0
    v_accvgpr_write_b32 a113, 0
    v_accvgpr_write_b32 a114, 0
    v_accvgpr_write_b32 a115, 0
    v_accvgpr_write_b32 a116, 0
    v_accvgpr_write_b32 a117, 0
    v_accvgpr_write_b32 a118, 0
    v_accvgpr_write_b32 a119, 0
    v_accvgpr_write_b32 a120, 0
    v_accvgpr_write_b32 a121, 0
    v_accvgpr_write_b32 a122, 0
    v_accvgpr_write_b32 a123, 0
    v_accvgpr_write_b32 a124, 0
    v_accvgpr_write_b32 a125, 0
    v_accvgpr_write_b32 a126, 0
    v_accvgpr_write_b32 a127, 0
    v_accvgpr_write_b32 a224, 0
    v_accvgpr_write_b32 a225, 0
    v_accvgpr_write_b32 a226, 0
    v_accvgpr_write_b32 a227, 0
    v_accvgpr_write_b32 a228, 0
    v_accvgpr_write_b32 a229, 0
    v_accvgpr_write_b32 a230, 0
    v_accvgpr_write_b32 a231, 0
    v_mov_b32 v216, 0
    v_mov_b32 v217, 0
    v_mov_b32 v218, 0
    v_mov_b32 v219, 0
    v_mov_b32 v220, 0
    v_mov_b32 v221, 0
    v_mov_b32 v222, 0
    v_mov_b32 v223, 0
    v_mov_b32 v224, 0
    v_mov_b32 v225, 0
    v_mov_b32 v226, 0
    v_mov_b32 v227, 0
    v_mov_b32 v228, 0
    v_mov_b32 v229, 0
    v_mov_b32 v230, 0
    v_mov_b32 v231, 0
    s_mov_b32 s24, 0
L_fb2:
    s_mov_b32 m0, s23
    s_add_u32 s48, s24, 0
    buffer_load_dwordx4 v200, s[4:7], s48 offen lds
    buffer_load_dwordx4 v201, s[4:7], s48 offen offset:1024 lds
    buffer_load_dwordx4 v202, s[4:7], s48 offen offset:2048 lds
    buffer_load_dwordx4 v203, s[4:7], s48 offen offset:3072 lds
    s_mov_b32 m0, s47
    s_add_u32 s48, s24, 4096
    buffer_load_dwordx4 v200, s[4:7], s48 offen lds
    buffer_load_dwordx4 v201, s[4:7], s48 offen offset:1024 lds
    buffer_load_dwordx4 v202, s[4:7], s48 offen offset:2048 lds
    buffer_load_dwordx4 v203, s[4:7], s48 offen offset:3072 lds
    s_waitcnt vmcnt(0)
    ds_read_b128 a[128:131], v204 offset:32768
    ds_read_b128 a[132:135], v205 offset:32768
    ds_read_b128 a[136:139], v206 offset:32768
    ds_read_b128 a[140:143], v207 offset:32768
    ds_read_b128 a[144:147], v204 offset:36864
    ds_read_b128 a[148:151], v205 offset:36864
    ds_read_b128 a[152:155], v206 offset:36864
    ds_read_b128 a[156:159], v207 offset:36864
    s_waitcnt lgkmcnt(0)
    s_mov_b32 m0, s23
    s_add_u32 s48, s24, 0
    buffer_load_dwordx4 v232, s[8:11], s48 offen lds
    buffer_load_dwordx4 v233, s[8:11], s48 offen offset:1024 lds
    buffer_load_dwordx4 v232, s[8:11], s48 offen offset:2048 lds
    buffer_load_dwordx4 v233, s[8:11], s48 offen offset:3072 lds
    s_mov_b32 m0, s47
    s_add_u32 s48, s24, 4096
    buffer_load_dwordx4 v232, s[8:11], s48 offen lds
    buffer_load_dwordx4 v233, s[8:11], s48 offen offset:1024 lds
    buffer_load_dwordx4 v232, s[8:11], s48 offen offset:2048 lds
    buffer_load_dwordx4 v233, s[8:11], s48 offen offset:3072 lds
    v_mfma_f32_16x16x32_bf16 v[0:3], a[128:131], v[112:115], v[96:99]
    v_mfma_f32_16x16x32_bf16 v[0:3], a[132:135], v[116:119], v[0:3]
    v_mfma_f32_16x16x32_bf16 v[0:3], a[136:139], v[120:123], v[0:3]
    v_mfma_f32_16x16x32_bf16 v[0:3], a[140:143], v[124:127], v[0:3]
    v_mfma_f32_16x16x32_bf16 v[4:7], a[144:147], v[112:115], v[96:99]
    v_mfma_f32_16x16x32_bf16 v[4:7], a[148:151], v[116:119], v[4:7]
    v_mfma_f32_16x16x32_bf16 v[4:7], a[152:155], v[120:123], v[4:7]
    v_mfma_f32_16x16x32_bf16 v[4:7], a[156:159], v[124:127], v[4:7]
    v_mfma_f32_16x16x32_bf16 v[8:11], a[128:131], v[128:131], v[100:103]
    v_mfma_f32_16x16x32_bf16 v[8:11], a[132:135], v[132:135], v[8:11]
    v_mfma_f32_16x16x32_bf16 v[8:11], a[136:139], v[136:139], v[8:11]
    v_mfma_f32_16x16x32_bf16 v[8:11], a[140:143], v[140:143], v[8:11]
    v_mfma_f32_16x16x32_bf16 v[12:15], a[144:147], v[128:131], v[100:103]
    v_mfma_f32_16x16x32_bf16 v[12:15], a[148:151], v[132:135], v[12:15]
    v_mfma_f32_16x16x32_bf16 v[12:15], a[152:155], v[136:139], v[12:15]
    v_mfma_f32_16x16x32_bf16 v[12:15], a[156:159], v[140:143], v[12:15]
    v_mfma_f32_16x16x32_bf16 v[16:19], a[128:131], v[144:147], v[104:107]
    v_mfma_f32_16x16x32_bf16 v[16:19], a[132:135], v[148:151], v[16:19]
    v_mfma_f32_16x16x32_bf16 v[16:19], a[136:139], v[152:155], v[16:19]
    v_mfma_f32_16x16x32_bf16 v[16:19], a[140:143], v[156:159], v[16:19]
    v_mfma_f32_16x16x32_bf16 v[20:23], a[144:147], v[144:147], v[104:107]
    v_mfma_f32_16x16x32_bf16 v[20:23], a[148:151], v[148:151], v[20:23]
    v_mfma_f32_16x16x32_bf16 v[20:23], a[152:155], v[152:155], v[20:23]
    v_mfma_f32_16x16x32_bf16 v[20:23], a[156:159], v[156:159], v[20:23]
    v_mfma_f32_16x16x32_bf16 v[24:27], a[128:131], v[160:163], v[108:111]
    v_mfma_f32_16x16x32_bf16 v[24:27], a[132:135], v[164:167], v[24:27]
    v_mfma_f32_16x16x32_bf16 v[24:27], a[136:139], v[168:171], v[24:27]
    v_mfma_f32_16x16x32_bf16 v[24:27], a[140:143], v[172:175], v[24:27]
    v_mfma_f32_16x16x32_bf16 v[28:31], a[144:147], v[160:163], v[108:111]
    v_mfma_f32_16x16x32_bf16 v[28:31], a[148:151], v[164:167], v[28:31]
    v_mfma_f32_16x16x32_bf16 v[28:31], a[152:155], v[168:171], v[28:31]
    v_mfma_f32_16x16x32_bf16 v[28:31], a[156:159], v[172:175], v[28:31]
    s_nop 15
    v_exp_f32 v0, v0
    v_exp_f32 v1, v1
    s_nop 0
    v_cvt_pk_bf16_f32 v64, v0, v1
    v_exp_f32 v2, v2
    v_exp_f32 v3, v3
    s_nop 0
    v_cvt_pk_bf16_f32 v65, v2, v3
    v_exp_f32 v4, v4
    v_exp_f32 v5, v5
    s_nop 0
    v_cvt_pk_bf16_f32 v66, v4, v5
    v_exp_f32 v6, v6
    v_exp_f32 v7, v7
    s_nop 0
    v_cvt_pk_bf16_f32 v67, v6, v7
    v_exp_f32 v8, v8
    v_exp_f32 v9, v9
    s_nop 0
    v_cvt_pk_bf16_f32 v68, v8, v9
    v_exp_f32 v10, v10
    v_exp_f32 v11, v11
    s_nop 0
    v_cvt_pk_bf16_f32 v69, v10, v11
    v_exp_f32 v12, v12
    v_exp_f32 v13, v13
    s_nop 0
    v_cvt_pk_bf16_f32 v70, v12, v13
    v_exp_f32 v14, v14
    v_exp_f32 v15, v15
    s_nop 0
    v_cvt_pk_bf16_f32 v71, v14, v15
    v_exp_f32 v16, v16
    v_exp_f32 v17, v17
    s_nop 0
    v_cvt_pk_bf16_f32 v72, v16, v17
    v_exp_f32 v18, v18
    v_exp_f32 v19, v19
    s_nop 0
    v_cvt_pk_bf16_f32 v73, v18, v19
    v_exp_f32 v20, v20
    v_exp_f32 v21, v21
    s_nop 0
    v_cvt_pk_bf16_f32 v74, v20, v21
    v_exp_f32 v22, v22
    v_exp_f32 v23, v23
    s_nop 0
    v_cvt_pk_bf16_f32 v75, v22, v23
    v_exp_f32 v24, v24
    v_exp_f32 v25, v25
    s_nop 0
    v_cvt_pk_bf16_f32 v76, v24, v25
    v_exp_f32 v26, v26
    v_exp_f32 v27, v27
    s_nop 0
    v_cvt_pk_bf16_f32 v77, v26, v27
    v_exp_f32 v28, v28
    v_exp_f32 v29, v29
    s_nop 0
    v_cvt_pk_bf16_f32 v78, v28, v29
    v_exp_f32 v30, v30
    v_exp_f32 v31, v31
    s_nop 0
    v_cvt_pk_bf16_f32 v79, v30, v31
    s_waitcnt vmcnt(0)
    ds_read_b64_tr_b16 a[160:161], v180 offset:0
    ds_read_b64_tr_b16 a[162:163], v180 offset:4096
    ds_read_b64_tr_b16 a[164:165], v181 offset:0
    ds_read_b64_tr_b16 a[166:167], v181 offset:4096
    ds_read_b64_tr_b16 a[168:169], v182 offset:0
    ds_read_b64_tr_b16 a[170:171], v182 offset:4096
    ds_read_b64_tr_b16 a[172:173], v183 offset:0
    ds_read_b64_tr_b16 a[174:175], v183 offset:4096
    ds_read_b64_tr_b16 a[176:177], v184 offset:0
    ds_read_b64_tr_b16 a[178:179], v184 offset:4096
    ds_read_b64_tr_b16 a[180:181], v185 offset:0
    ds_read_b64_tr_b16 a[182:183], v185 offset:4096
    ds_read_b64_tr_b16 a[184:185], v186 offset:0
    ds_read_b64_tr_b16 a[186:187], v186 offset:4096
    ds_read_b64_tr_b16 a[188:189], v187 offset:0
    ds_read_b64_tr_b16 a[190:191], v187 offset:4096
    s_waitcnt lgkmcnt(0)
    v_mfma_f32_16x16x32_bf16 a[0:3], v[64:67], a[160:163], a[0:3]
    v_mfma_f32_16x16x32_bf16 a[32:35], v[68:71], a[160:163], a[32:35]
    v_mfma_f32_16x16x32_bf16 a[64:67], v[72:75], a[160:163], a[64:67]
    v_mfma_f32_16x16x32_bf16 a[96:99], v[76:79], a[160:163], a[96:99]
    v_mfma_f32_16x16x32_bf16 a[4:7], v[64:67], a[164:167], a[4:7]
    v_mfma_f32_16x16x32_bf16 a[36:39], v[68:71], a[164:167], a[36:39]
    v_mfma_f32_16x16x32_bf16 a[68:71], v[72:75], a[164:167], a[68:71]
    v_mfma_f32_16x16x32_bf16 a[100:103], v[76:79], a[164:167], a[100:103]
    v_mfma_f32_16x16x32_bf16 a[8:11], v[64:67], a[168:171], a[8:11]
    v_mfma_f32_16x16x32_bf16 a[40:43], v[68:71], a[168:171], a[40:43]
    v_mfma_f32_16x16x32_bf16 a[72:75], v[72:75], a[168:171], a[72:75]
    v_mfma_f32_16x16x32_bf16 a[104:107], v[76:79], a[168:171], a[104:107]
    v_mfma_f32_16x16x32_bf16 a[12:15], v[64:67], a[172:175], a[12:15]
    v_mfma_f32_16x16x32_bf16 a[44:47], v[68:71], a[172:175], a[44:47]
    v_mfma_f32_16x16x32_bf16 a[76:79], v[72:75], a[172:175], a[76:79]
    v_mfma_f32_16x16x32_bf16 a[108:111], v[76:79], a[172:175], a[108:111]
    v_mfma_f32_16x16x32_bf16 a[16:19], v[64:67], a[176:179], a[16:19]
    v_mfma_f32_16x16x32_bf16 a[48:51], v[68:71], a[176:179], a[48:51]
    v_mfma_f32_16x16x32_bf16 a[80:83], v[72:75], a[176:179], a[80:83]
    v_mfma_f32_16x16x32_bf16 a[112:115], v[76:79], a[176:179], a[112:115]
    v_mfma_f32_16x16x32_bf16 a[20:23], v[64:67], a[180:183], a[20:23]
    v_mfma_f32_16x16x32_bf16 a[52:55], v[68:71], a[180:183], a[52:55]
    v_mfma_f32_16x16x32_bf16 a[84:87], v[72:75], a[180:183], a[84:87]
    v_mfma_f32_16x16x32_bf16 a[116:119], v[76:79], a[180:183], a[116:119]
    v_mfma_f32_16x16x32_bf16 a[24:27], v[64:67], a[184:187], a[24:27]
    v_mfma_f32_16x16x32_bf16 a[56:59], v[68:71], a[184:187], a[56:59]
    v_mfma_f32_16x16x32_bf16 a[88:91], v[72:75], a[184:187], a[88:91]
    v_mfma_f32_16x16x32_bf16 a[120:123], v[76:79], a[184:187], a[120:123]
    v_mfma_f32_16x16x32_bf16 a[28:31], v[64:67], a[188:191], a[28:31]
    v_mfma_f32_16x16x32_bf16 a[60:63], v[68:71], a[188:191], a[60:63]
    v_mfma_f32_16x16x32_bf16 a[92:95], v[72:75], a[188:191], a[92:95]
    v_mfma_f32_16x16x32_bf16 a[124:127], v[76:79], a[188:191], a[124:127]
    v_smfmac_f32_16x16x64_bf16 a[224:227], v[192:195], v[64:71], v196
    v_smfmac_f32_16x16x64_bf16 a[228:231], v[192:195], v[72:79], v196
    s_add_u32 s24, s24, 8192
    s_cmp_lt_u32 s24, 0x80000
    s_nop 15
    s_cbranch_scc1 L_fb2
    v_accvgpr_read_b32 v250, a224
    v_accvgpr_read_b32 v251, a225
    v_add_f32 v251, v250, v251
    v_rcp_f32 v250, v251
    v_accvgpr_read_b32 v232, a0
    v_accvgpr_read_b32 v233, a1
    v_mfma_f32_16x16x4_f32 v[96:99], v250, v199, 0
    v_accvgpr_read_b32 v236, a4
    v_accvgpr_read_b32 v237, a5
    v_accvgpr_read_b32 v240, a8
    v_accvgpr_read_b32 v241, a9
    v_accvgpr_read_b32 v244, a12
    v_accvgpr_read_b32 v245, a13
    v_accvgpr_read_b32 v234, a2
    v_accvgpr_read_b32 v235, a3
    v_accvgpr_read_b32 v238, a6
    v_accvgpr_read_b32 v239, a7
    v_accvgpr_read_b32 v242, a10
    v_accvgpr_read_b32 v243, a11
    v_pk_mul_f32 v[216:217], v[216:217], v[96:97]
    v_pk_fma_f32 v[232:233], v[232:233], v[96:97], v[216:217] neg_lo:[0,0,1] neg_hi:[0,0,1]
    v_pk_fma_f32 v[236:237], v[236:237], v[96:97], v[216:217] neg_lo:[0,0,1] neg_hi:[0,0,1]
    v_pk_fma_f32 v[240:241], v[240:241], v[96:97], v[216:217] neg_lo:[0,0,1] neg_hi:[0,0,1]
    v_pk_fma_f32 v[244:245], v[244:245], v[96:97], v[216:217] neg_lo:[0,0,1] neg_hi:[0,0,1]
    v_cvt_pk_bf16_f32 v0, v232, v236
    v_cvt_pk_bf16_f32 v1, v240, v244
    v_cvt_pk_bf16_f32 v2, v233, v237
    v_cvt_pk_bf16_f32 v3, v241, v245
    v_pk_mul_f32 v[218:219], v[218:219], v[98:99]
    v_accvgpr_read_b32 v246, a14
    v_accvgpr_read_b32 v247, a15
    v_pk_fma_f32 v[234:235], v[234:235], v[98:99], v[218:219] neg_lo:[0,0,1] neg_hi:[0,0,1]
    v_pk_fma_f32 v[238:239], v[238:239], v[98:99], v[218:219] neg_lo:[0,0,1] neg_hi:[0,0,1]
    v_pk_fma_f32 v[242:243], v[242:243], v[98:99], v[218:219] neg_lo:[0,0,1] neg_hi:[0,0,1]
    v_pk_fma_f32 v[246:247], v[246:247], v[98:99], v[218:219] neg_lo:[0,0,1] neg_hi:[0,0,1]
    v_cvt_pk_bf16_f32 v4, v234, v238
    v_cvt_pk_bf16_f32 v5, v242, v246
    v_cvt_pk_bf16_f32 v6, v235, v239
    v_cvt_pk_bf16_f32 v7, v243, v247
    ds_write_b64 v208, v[0:1] offset:0
    ds_write_b64 v209, v[2:3] offset:256
    ds_write_b64 v208, v[4:5] offset:640
    ds_write_b64 v209, v[6:7] offset:896
    ds_read_b64_tr_b16 v[0:1], v210 offset:0
    ds_read_b64_tr_b16 v[2:3], v211 offset:0
    ds_read_b64_tr_b16 v[4:5], v210 offset:2048
    ds_read_b64_tr_b16 v[6:7], v211 offset:2048
    v_accvgpr_read_b32 v232, a16
    v_accvgpr_read_b32 v233, a17
    v_accvgpr_read_b32 v236, a20
    v_accvgpr_read_b32 v237, a21
    v_accvgpr_read_b32 v240, a24
    v_accvgpr_read_b32 v241, a25
    v_accvgpr_read_b32 v244, a28
    v_accvgpr_read_b32 v245, a29
    v_pk_fma_f32 v[232:233], v[232:233], v[96:97], v[216:217] neg_lo:[0,0,1] neg_hi:[0,0,1]
    v_pk_fma_f32 v[236:237], v[236:237], v[96:97], v[216:217] neg_lo:[0,0,1] neg_hi:[0,0,1]
    v_pk_fma_f32 v[240:241], v[240:241], v[96:97], v[216:217] neg_lo:[0,0,1] neg_hi:[0,0,1]
    v_pk_fma_f32 v[244:245], v[244:245], v[96:97], v[216:217] neg_lo:[0,0,1] neg_hi:[0,0,1]
    s_waitcnt lgkmcnt(2)
    buffer_store_dwordx4 v[0:3], v248, s[16:19], 0 offen sc1
    s_waitcnt lgkmcnt(0)
    buffer_store_dwordx4 v[4:7], v248, s[16:19], 0 offen offset:2048 sc1
    v_cvt_pk_bf16_f32 v32, v232, v236
    v_cvt_pk_bf16_f32 v33, v240, v244
    v_cvt_pk_bf16_f32 v34, v233, v237
    v_cvt_pk_bf16_f32 v35, v241, v245
    v_accvgpr_read_b32 v234, a18
    v_accvgpr_read_b32 v235, a19
    v_accvgpr_read_b32 v238, a22
    v_accvgpr_read_b32 v239, a23
    v_accvgpr_read_b32 v242, a26
    v_accvgpr_read_b32 v243, a27
    v_accvgpr_read_b32 v246, a30
    v_accvgpr_read_b32 v247, a31
    v_pk_fma_f32 v[234:235], v[234:235], v[98:99], v[218:219] neg_lo:[0,0,1] neg_hi:[0,0,1]
    v_pk_fma_f32 v[238:239], v[238:239], v[98:99], v[218:219] neg_lo:[0,0,1] neg_hi:[0,0,1]
    v_pk_fma_f32 v[242:243], v[242:243], v[98:99], v[218:219] neg_lo:[0,0,1] neg_hi:[0,0,1]
    v_pk_fma_f32 v[246:247], v[246:247], v[98:99], v[218:219] neg_lo:[0,0,1] neg_hi:[0,0,1]
    v_cvt_pk_bf16_f32 v36, v234, v238
    v_cvt_pk_bf16_f32 v37, v242, v246
    v_cvt_pk_bf16_f32 v38, v235, v239
    v_cvt_pk_bf16_f32 v39, v243, v247
    ds_write_b64 v208, v[32:33] offset:128
    ds_write_b64 v209, v[34:35] offset:384
    ds_write_b64 v208, v[36:37] offset:512
    ds_write_b64 v209, v[38:39] offset:768
    ds_read_b64_tr_b16 v[32:33], v252 offset:0
    ds_read_b64_tr_b16 v[34:35], v253 offset:0
    ds_read_b64_tr_b16 v[36:37], v252 offset:2048
    ds_read_b64_tr_b16 v[38:39], v253 offset:2048
    v_accvgpr_read_b32 v250, a226
    v_accvgpr_read_b32 v251, a227
    v_add_f32 v251, v250, v251
    v_rcp_f32 v250, v251
    v_accvgpr_read_b32 v232, a32
    v_accvgpr_read_b32 v233, a33
    v_mfma_f32_16x16x4_f32 v[100:103], v250, v199, 0
    v_accvgpr_read_b32 v236, a36
    v_accvgpr_read_b32 v237, a37
    v_accvgpr_read_b32 v240, a40
    s_waitcnt lgkmcnt(2)
    buffer_store_dwordx4 v[32:35], v248, s[16:19], 0 offen offset:128 sc1
    s_waitcnt lgkmcnt(0)
    buffer_store_dwordx4 v[36:39], v248, s[16:19], 0 offen offset:2176 sc1
    v_accvgpr_read_b32 v241, a41
    v_accvgpr_read_b32 v244, a44
    v_accvgpr_read_b32 v245, a45
    v_accvgpr_read_b32 v234, a34
    v_accvgpr_read_b32 v235, a35
    v_accvgpr_read_b32 v238, a38
    v_accvgpr_read_b32 v239, a39
    v_pk_mul_f32 v[220:221], v[220:221], v[100:101]
    v_pk_fma_f32 v[232:233], v[232:233], v[100:101], v[220:221] neg_lo:[0,0,1] neg_hi:[0,0,1]
    v_pk_fma_f32 v[236:237], v[236:237], v[100:101], v[220:221] neg_lo:[0,0,1] neg_hi:[0,0,1]
    v_pk_fma_f32 v[240:241], v[240:241], v[100:101], v[220:221] neg_lo:[0,0,1] neg_hi:[0,0,1]
    v_pk_fma_f32 v[244:245], v[244:245], v[100:101], v[220:221] neg_lo:[0,0,1] neg_hi:[0,0,1]
    v_cvt_pk_bf16_f32 v8, v232, v236
    v_cvt_pk_bf16_f32 v9, v240, v244
    v_cvt_pk_bf16_f32 v10, v233, v237
    v_cvt_pk_bf16_f32 v11, v241, v245
    v_pk_mul_f32 v[222:223], v[222:223], v[102:103]
    v_accvgpr_read_b32 v242, a42
    v_accvgpr_read_b32 v243, a43
    v_accvgpr_read_b32 v246, a46
    v_accvgpr_read_b32 v247, a47
    v_pk_fma_f32 v[234:235], v[234:235], v[102:103], v[222:223] neg_lo:[0,0,1] neg_hi:[0,0,1]
    v_pk_fma_f32 v[238:239], v[238:239], v[102:103], v[222:223] neg_lo:[0,0,1] neg_hi:[0,0,1]
    v_pk_fma_f32 v[242:243], v[242:243], v[102:103], v[222:223] neg_lo:[0,0,1] neg_hi:[0,0,1]
    v_pk_fma_f32 v[246:247], v[246:247], v[102:103], v[222:223] neg_lo:[0,0,1] neg_hi:[0,0,1]
    v_cvt_pk_bf16_f32 v12, v234, v238
    v_cvt_pk_bf16_f32 v13, v242, v246
    v_cvt_pk_bf16_f32 v14, v235, v239
    v_cvt_pk_bf16_f32 v15, v243, v247
    ds_write_b64 v208, v[8:9] offset:4096
    ds_write_b64 v209, v[10:11] offset:4352
    ds_write_b64 v208, v[12:13] offset:4736
    ds_write_b64 v209, v[14:15] offset:4992
    ds_read_b64_tr_b16 v[8:9], v210 offset:4096
    ds_read_b64_tr_b16 v[10:11], v211 offset:4096
    ds_read_b64_tr_b16 v[12:13], v210 offset:6144
    ds_read_b64_tr_b16 v[14:15], v211 offset:6144
    v_accvgpr_read_b32 v232, a48
    v_accvgpr_read_b32 v233, a49
    v_accvgpr_read_b32 v236, a52
    v_accvgpr_read_b32 v237, a53
    v_accvgpr_read_b32 v240, a56
    v_accvgpr_read_b32 v241, a57
    v_accvgpr_read_b32 v244, a60
    v_accvgpr_read_b32 v245, a61
    v_pk_fma_f32 v[232:233], v[232:233], v[100:101], v[220:221] neg_lo:[0,0,1] neg_hi:[0,0,1]
    v_pk_fma_f32 v[236:237], v[236:237], v[100:101], v[220:221] neg_lo:[0,0,1] neg_hi:[0,0,1]
    v_pk_fma_f32 v[240:241], v[240:241], v[100:101], v[220:221] neg_lo:[0,0,1] neg_hi:[0,0,1]
    v_pk_fma_f32 v[244:245], v[244:245], v[100:101], v[220:221] neg_lo:[0,0,1] neg_hi:[0,0,1]
    s_waitcnt lgkmcnt(2)
    buffer_store_dwordx4 v[8:11], v248, s[16:19], s42 offen sc1
    s_waitcnt lgkmcnt(0)
    buffer_store_dwordx4 v[12:15], v248, s[16:19], s42 offen offset:2048 sc1
    v_cvt_pk_bf16_f32 v40, v232, v236
    v_cvt_pk_bf16_f32 v41, v240, v244
    v_cvt_pk_bf16_f32 v42, v233, v237
    v_cvt_pk_bf16_f32 v43, v241, v245
    v_accvgpr_read_b32 v234, a50
    v_accvgpr_read_b32 v235, a51
    v_accvgpr_read_b32 v238, a54
    v_accvgpr_read_b32 v239, a55
    v_accvgpr_read_b32 v242, a58
    v_accvgpr_read_b32 v243, a59
    v_accvgpr_read_b32 v246, a62
    v_accvgpr_read_b32 v247, a63
    v_pk_fma_f32 v[234:235], v[234:235], v[102:103], v[222:223] neg_lo:[0,0,1] neg_hi:[0,0,1]
    v_pk_fma_f32 v[238:239], v[238:239], v[102:103], v[222:223] neg_lo:[0,0,1] neg_hi:[0,0,1]
    v_pk_fma_f32 v[242:243], v[242:243], v[102:103], v[222:223] neg_lo:[0,0,1] neg_hi:[0,0,1]
    v_pk_fma_f32 v[246:247], v[246:247], v[102:103], v[222:223] neg_lo:[0,0,1] neg_hi:[0,0,1]
    v_cvt_pk_bf16_f32 v44, v234, v238
    v_cvt_pk_bf16_f32 v45, v242, v246
    v_cvt_pk_bf16_f32 v46, v235, v239
    v_cvt_pk_bf16_f32 v47, v243, v247
    ds_write_b64 v208, v[40:41] offset:4224
    ds_write_b64 v209, v[42:43] offset:4480
    ds_write_b64 v208, v[44:45] offset:4608
    ds_write_b64 v209, v[46:47] offset:4864
    ds_read_b64_tr_b16 v[40:41], v252 offset:4096
    ds_read_b64_tr_b16 v[42:43], v253 offset:4096
    ds_read_b64_tr_b16 v[44:45], v252 offset:6144
    ds_read_b64_tr_b16 v[46:47], v253 offset:6144
    v_accvgpr_read_b32 v250, a228
    v_accvgpr_read_b32 v251, a229
    v_add_f32 v251, v250, v251
    v_rcp_f32 v250, v251
    v_accvgpr_read_b32 v232, a64
    v_accvgpr_read_b32 v233, a65
    v_mfma_f32_16x16x4_f32 v[104:107], v250, v199, 0
    v_accvgpr_read_b32 v236, a68
    v_accvgpr_read_b32 v237, a69
    v_accvgpr_read_b32 v240, a72
    s_waitcnt lgkmcnt(2)
    buffer_store_dwordx4 v[40:43], v248, s[16:19], s42 offen offset:128 sc1
    s_waitcnt lgkmcnt(0)
    buffer_store_dwordx4 v[44:47], v248, s[16:19], s42 offen offset:2176 sc1
    v_accvgpr_read_b32 v241, a73
    v_accvgpr_read_b32 v244, a76
    v_accvgpr_read_b32 v245, a77
    v_accvgpr_read_b32 v234, a66
    v_accvgpr_read_b32 v235, a67
    v_accvgpr_read_b32 v238, a70
    v_accvgpr_read_b32 v239, a71
    v_pk_mul_f32 v[224:225], v[224:225], v[104:105]
    v_pk_fma_f32 v[232:233], v[232:233], v[104:105], v[224:225] neg_lo:[0,0,1] neg_hi:[0,0,1]
    v_pk_fma_f32 v[236:237], v[236:237], v[104:105], v[224:225] neg_lo:[0,0,1] neg_hi:[0,0,1]
    v_pk_fma_f32 v[240:241], v[240:241], v[104:105], v[224:225] neg_lo:[0,0,1] neg_hi:[0,0,1]
    v_pk_fma_f32 v[244:245], v[244:245], v[104:105], v[224:225] neg_lo:[0,0,1] neg_hi:[0,0,1]
    v_cvt_pk_bf16_f32 v16, v232, v236
    v_cvt_pk_bf16_f32 v17, v240, v244
    v_cvt_pk_bf16_f32 v18, v233, v237
    v_cvt_pk_bf16_f32 v19, v241, v245
    v_pk_mul_f32 v[226:227], v[226:227], v[106:107]
    v_accvgpr_read_b32 v242, a74
    v_accvgpr_read_b32 v243, a75
    v_accvgpr_read_b32 v246, a78
    v_accvgpr_read_b32 v247, a79
    v_pk_fma_f32 v[234:235], v[234:235], v[106:107], v[226:227] neg_lo:[0,0,1] neg_hi:[0,0,1]
    v_pk_fma_f32 v[238:239], v[238:239], v[106:107], v[226:227] neg_lo:[0,0,1] neg_hi:[0,0,1]
    v_pk_fma_f32 v[242:243], v[242:243], v[106:107], v[226:227] neg_lo:[0,0,1] neg_hi:[0,0,1]
    v_pk_fma_f32 v[246:247], v[246:247], v[106:107], v[226:227] neg_lo:[0,0,1] neg_hi:[0,0,1]
    v_cvt_pk_bf16_f32 v20, v234, v238
    v_cvt_pk_bf16_f32 v21, v242, v246
    v_cvt_pk_bf16_f32 v22, v235, v239
    v_cvt_pk_bf16_f32 v23, v243, v247
    ds_write_b64 v208, v[16:17] offset:0
    ds_write_b64 v209, v[18:19] offset:256
    ds_write_b64 v208, v[20:21] offset:640
    ds_write_b64 v209, v[22:23] offset:896
    ds_read_b64_tr_b16 v[16:17], v210 offset:0
    ds_read_b64_tr_b16 v[18:19], v211 offset:0
    ds_read_b64_tr_b16 v[20:21], v210 offset:2048
    ds_read_b64_tr_b16 v[22:23], v211 offset:2048
    v_accvgpr_read_b32 v232, a80
    v_accvgpr_read_b32 v233, a81
    v_accvgpr_read_b32 v236, a84
    v_accvgpr_read_b32 v237, a85
    v_accvgpr_read_b32 v240, a88
    v_accvgpr_read_b32 v241, a89
    v_accvgpr_read_b32 v244, a92
    v_accvgpr_read_b32 v245, a93
    v_pk_fma_f32 v[232:233], v[232:233], v[104:105], v[224:225] neg_lo:[0,0,1] neg_hi:[0,0,1]
    v_pk_fma_f32 v[236:237], v[236:237], v[104:105], v[224:225] neg_lo:[0,0,1] neg_hi:[0,0,1]
    v_pk_fma_f32 v[240:241], v[240:241], v[104:105], v[224:225] neg_lo:[0,0,1] neg_hi:[0,0,1]
    v_pk_fma_f32 v[244:245], v[244:245], v[104:105], v[224:225] neg_lo:[0,0,1] neg_hi:[0,0,1]
    s_waitcnt lgkmcnt(2)
    buffer_store_dwordx4 v[16:19], v248, s[16:19], s43 offen sc1
    s_waitcnt lgkmcnt(0)
    buffer_store_dwordx4 v[20:23], v248, s[16:19], s43 offen offset:2048 sc1
    v_cvt_pk_bf16_f32 v48, v232, v236
    v_cvt_pk_bf16_f32 v49, v240, v244
    v_cvt_pk_bf16_f32 v50, v233, v237
    v_cvt_pk_bf16_f32 v51, v241, v245
    v_accvgpr_read_b32 v234, a82
    v_accvgpr_read_b32 v235, a83
    v_accvgpr_read_b32 v238, a86
    v_accvgpr_read_b32 v239, a87
    v_accvgpr_read_b32 v242, a90
    v_accvgpr_read_b32 v243, a91
    v_accvgpr_read_b32 v246, a94
    v_accvgpr_read_b32 v247, a95
    v_pk_fma_f32 v[234:235], v[234:235], v[106:107], v[226:227] neg_lo:[0,0,1] neg_hi:[0,0,1]
    v_pk_fma_f32 v[238:239], v[238:239], v[106:107], v[226:227] neg_lo:[0,0,1] neg_hi:[0,0,1]
    v_pk_fma_f32 v[242:243], v[242:243], v[106:107], v[226:227] neg_lo:[0,0,1] neg_hi:[0,0,1]
    v_pk_fma_f32 v[246:247], v[246:247], v[106:107], v[226:227] neg_lo:[0,0,1] neg_hi:[0,0,1]
    v_cvt_pk_bf16_f32 v52, v234, v238
    v_cvt_pk_bf16_f32 v53, v242, v246
    v_cvt_pk_bf16_f32 v54, v235, v239
    v_cvt_pk_bf16_f32 v55, v243, v247
    ds_write_b64 v208, v[48:49] offset:128
    ds_write_b64 v209, v[50:51] offset:384
    ds_write_b64 v208, v[52:53] offset:512
    ds_write_b64 v209, v[54:55] offset:768
    ds_read_b64_tr_b16 v[48:49], v252 offset:0
    ds_read_b64_tr_b16 v[50:51], v253 offset:0
    ds_read_b64_tr_b16 v[52:53], v252 offset:2048
    ds_read_b64_tr_b16 v[54:55], v253 offset:2048
    v_accvgpr_read_b32 v250, a230
    v_accvgpr_read_b32 v251, a231
    v_add_f32 v251, v250, v251
    v_rcp_f32 v250, v251
    v_accvgpr_read_b32 v232, a96
    v_accvgpr_read_b32 v233, a97
    v_mfma_f32_16x16x4_f32 v[108:111], v250, v199, 0
    v_accvgpr_read_b32 v236, a100
    v_accvgpr_read_b32 v237, a101
    v_accvgpr_read_b32 v240, a104
    s_waitcnt lgkmcnt(2)
    buffer_store_dwordx4 v[48:51], v248, s[16:19], s43 offen offset:128 sc1
    s_waitcnt lgkmcnt(0)
    buffer_store_dwordx4 v[52:55], v248, s[16:19], s43 offen offset:2176 sc1
    v_accvgpr_read_b32 v241, a105
    v_accvgpr_read_b32 v244, a108
    v_accvgpr_read_b32 v245, a109
    v_accvgpr_read_b32 v234, a98
    v_accvgpr_read_b32 v235, a99
    v_accvgpr_read_b32 v238, a102
    v_accvgpr_read_b32 v239, a103
    v_pk_mul_f32 v[228:229], v[228:229], v[108:109]
    v_pk_fma_f32 v[232:233], v[232:233], v[108:109], v[228:229] neg_lo:[0,0,1] neg_hi:[0,0,1]
    v_pk_fma_f32 v[236:237], v[236:237], v[108:109], v[228:229] neg_lo:[0,0,1] neg_hi:[0,0,1]
    v_pk_fma_f32 v[240:241], v[240:241], v[108:109], v[228:229] neg_lo:[0,0,1] neg_hi:[0,0,1]
    v_pk_fma_f32 v[244:245], v[244:245], v[108:109], v[228:229] neg_lo:[0,0,1] neg_hi:[0,0,1]
    v_cvt_pk_bf16_f32 v24, v232, v236
    v_cvt_pk_bf16_f32 v25, v240, v244
    v_cvt_pk_bf16_f32 v26, v233, v237
    v_cvt_pk_bf16_f32 v27, v241, v245
    v_pk_mul_f32 v[230:231], v[230:231], v[110:111]
    v_accvgpr_read_b32 v242, a106
    v_accvgpr_read_b32 v243, a107
    v_accvgpr_read_b32 v246, a110
    v_accvgpr_read_b32 v247, a111
    v_pk_fma_f32 v[234:235], v[234:235], v[110:111], v[230:231] neg_lo:[0,0,1] neg_hi:[0,0,1]
    v_pk_fma_f32 v[238:239], v[238:239], v[110:111], v[230:231] neg_lo:[0,0,1] neg_hi:[0,0,1]
    v_pk_fma_f32 v[242:243], v[242:243], v[110:111], v[230:231] neg_lo:[0,0,1] neg_hi:[0,0,1]
    v_pk_fma_f32 v[246:247], v[246:247], v[110:111], v[230:231] neg_lo:[0,0,1] neg_hi:[0,0,1]
    v_cvt_pk_bf16_f32 v28, v234, v238
    v_cvt_pk_bf16_f32 v29, v242, v246
    v_cvt_pk_bf16_f32 v30, v235, v239
    v_cvt_pk_bf16_f32 v31, v243, v247
    ds_write_b64 v208, v[24:25] offset:4096
    ds_write_b64 v209, v[26:27] offset:4352
    ds_write_b64 v208, v[28:29] offset:4736
    ds_write_b64 v209, v[30:31] offset:4992
    ds_read_b64_tr_b16 v[24:25], v210 offset:4096
    ds_read_b64_tr_b16 v[26:27], v211 offset:4096
    ds_read_b64_tr_b16 v[28:29], v210 offset:6144
    ds_read_b64_tr_b16 v[30:31], v211 offset:6144
    v_accvgpr_read_b32 v232, a112
    v_accvgpr_read_b32 v233, a113
    v_accvgpr_read_b32 v236, a116
    v_accvgpr_read_b32 v237, a117
    v_accvgpr_read_b32 v240, a120
    v_accvgpr_read_b32 v241, a121
    v_accvgpr_read_b32 v244, a124
    v_accvgpr_read_b32 v245, a125
    v_pk_fma_f32 v[232:233], v[232:233], v[108:109], v[228:229] neg_lo:[0,0,1] neg_hi:[0,0,1]
    v_pk_fma_f32 v[236:237], v[236:237], v[108:109], v[228:229] neg_lo:[0,0,1] neg_hi:[0,0,1]
    v_pk_fma_f32 v[240:241], v[240:241], v[108:109], v[228:229] neg_lo:[0,0,1] neg_hi:[0,0,1]
    v_pk_fma_f32 v[244:245], v[244:245], v[108:109], v[228:229] neg_lo:[0,0,1] neg_hi:[0,0,1]
    s_waitcnt lgkmcnt(2)
    buffer_store_dwordx4 v[24:27], v248, s[16:19], s44 offen sc1
    s_waitcnt lgkmcnt(0)
    buffer_store_dwordx4 v[28:31], v248, s[16:19], s44 offen offset:2048 sc1
    v_cvt_pk_bf16_f32 v56, v232, v236
    v_cvt_pk_bf16_f32 v57, v240, v244
    v_cvt_pk_bf16_f32 v58, v233, v237
    v_cvt_pk_bf16_f32 v59, v241, v245
    v_accvgpr_read_b32 v234, a114
    v_accvgpr_read_b32 v235, a115
    v_accvgpr_read_b32 v238, a118
    v_accvgpr_read_b32 v239, a119
    v_accvgpr_read_b32 v242, a122
    v_accvgpr_read_b32 v243, a123
    v_accvgpr_read_b32 v246, a126
    v_accvgpr_read_b32 v247, a127
    v_pk_fma_f32 v[234:235], v[234:235], v[110:111], v[230:231] neg_lo:[0,0,1] neg_hi:[0,0,1]
    v_pk_fma_f32 v[238:239], v[238:239], v[110:111], v[230:231] neg_lo:[0,0,1] neg_hi:[0,0,1]
    v_pk_fma_f32 v[242:243], v[242:243], v[110:111], v[230:231] neg_lo:[0,0,1] neg_hi:[0,0,1]
    v_pk_fma_f32 v[246:247], v[246:247], v[110:111], v[230:231] neg_lo:[0,0,1] neg_hi:[0,0,1]
    v_cvt_pk_bf16_f32 v60, v234, v238
    v_cvt_pk_bf16_f32 v61, v242, v246
    v_cvt_pk_bf16_f32 v62, v235, v239
    v_cvt_pk_bf16_f32 v63, v243, v247
    ds_write_b64 v208, v[56:57] offset:4224
    ds_write_b64 v209, v[58:59] offset:4480
    ds_write_b64 v208, v[60:61] offset:4608
    ds_write_b64 v209, v[62:63] offset:4864
    ds_read_b64_tr_b16 v[56:57], v252 offset:4096
    ds_read_b64_tr_b16 v[58:59], v253 offset:4096
    ds_read_b64_tr_b16 v[60:61], v252 offset:6144
    ds_read_b64_tr_b16 v[62:63], v253 offset:6144
    s_waitcnt lgkmcnt(2)
    buffer_store_dwordx4 v[56:59], v248, s[16:19], s44 offen offset:128 sc1
    s_waitcnt lgkmcnt(0)
    buffer_store_dwordx4 v[60:63], v248, s[16:19], s44 offen offset:2176 sc1
    s_endpgm
.section .rodata,"a"
.p2align 6
.amdhsa_kernel standalone__gqa_softmax__prompt_kernel
  .amdhsa_next_free_vgpr 504
  .amdhsa_next_free_sgpr 64
  .amdhsa_accum_offset 256
  .amdhsa_group_segment_fixed_size 0
  .amdhsa_kernarg_size 48
  .amdhsa_user_sgpr_count 2
  .amdhsa_user_sgpr_kernarg_segment_ptr 1
  .amdhsa_system_sgpr_workgroup_id_x 1
.end_amdhsa_kernel
```
